```python
import torch

def _softmax(x, axis=-1):
    return torch.softmax(x, dim=axis)
def _gelu(x):
    return torch.nn.functional.gelu(x, approximate="tanh")
def _silu(x):
    return torch.nn.functional.silu(x)
def _sigmoid(x):
    return torch.sigmoid(x)
def _layernorm(x, axis=-1, eps=1e-5):
    m = x.mean(dim=axis, keepdim=True)
    v = x.var(dim=axis, keepdim=True, unbiased=False)
    return (x - m) / torch.sqrt(v + eps)
def _scatter_add(tgt, idx, src, axis=0):
    return tgt.clone().index_add_(axis, idx, src)
def _segment_sum(src, seg, n):
    out = torch.zeros((n,) + src.shape[1:], dtype=src.dtype)
    return out.index_add_(0, seg, src)
def _pad(x, pw):
    flat = tuple(v for pair in reversed(pw) for v in pair)
    return torch.nn.functional.pad(x, flat)

kernel_name = 'sequential_preLN__gqa_block_cached__mixer_channel_mlp__decode'

def setup_inputs():

    _w = (lambda a: (lambda t: t.to(torch.bfloat16) if t.is_floating_point() else t)(torch.as_tensor(a)))
    def _A_setup():
        B, Sq, D = 4, 1, 512
        Hq, Hkv, Sk, Dh = 32, 8, 4096, 128
        assert Hq % Hkv == 0, (Hq, Hkv)
        return {
            "x": _w((lambda *s: torch.randn(*s, dtype=torch.bfloat16) * 0.05)(B, Sq, D)),
            "k_cache": _w((lambda *s: torch.randn(*s, dtype=torch.bfloat16) * 3.2)(B, Hkv, Sk, Dh)),
            "v_cache": _w((lambda *s: torch.randn(*s, dtype=torch.bfloat16) * 0.4)(B, Hkv, Sk, Dh)),
            "wq": _w((lambda *s: torch.randn(*s, dtype=torch.bfloat16) * 3.2)(D, Hq * Dh) * (D ** -0.5)),
            "wo": _w((lambda *s: torch.randn(*s, dtype=torch.bfloat16) * 0.4)(Hq * Dh, D) * ((Hq * Dh) ** -0.5)),
        }
    _A_in = _A_setup()

    def _B_setup():
        B, S, D, F = 4, 1, 512, 1792
        return {
            "x": _w((lambda *s: torch.randn(*s, dtype=torch.bfloat16) * 0.05)(B, S, D)),
            "w1": _w((lambda *s: torch.randn(*s, dtype=torch.bfloat16) * 3.2)(D, F) * (D ** -0.5)),
            "b1": _w((lambda *s: torch.randn(*s, dtype=torch.bfloat16) * 3.2)(F)),
            "w2": _w((lambda *s: torch.randn(*s, dtype=torch.bfloat16) * 0.4)(F, D) * (F ** -0.5)),
            "b2": _w((lambda *s: torch.randn(*s, dtype=torch.bfloat16) * 0.8)(D)),
        }
    _B_in = _B_setup()

    return {
        "A_x": _A_in["x"],
        "A_k_cache": _A_in["k_cache"],
        "A_v_cache": _A_in["v_cache"],
        "A_wq": _A_in["wq"],
        "A_wo": _A_in["wo"],
        "B_x": _B_in["x"],
        "B_w1": _B_in["w1"],
        "B_b1": _B_in["b1"],
        "B_w2": _B_in["w2"],
        "B_b2": _B_in["b2"],
    }

def reference(A_x, A_k_cache, A_v_cache, A_wq, A_wo, B_x, B_w1, B_b1, B_w2, B_b2):
    def _A_ref(x, k_cache, v_cache, wq, wo):
        B, Sq, D = x.shape
        Hq, Dh = 32, 128
        Hkv = k_cache.shape[1]
        rep = Hq // Hkv
        q = (lambda x, *d: x.permute(*d))((x @ wq).reshape(B, Sq, Hq, Dh), 0, 2, 1, 3)
        k = (lambda x, n, axis: torch.repeat_interleave(x, n, dim=axis))(k_cache, rep, axis=1)
        v = (lambda x, n, axis: torch.repeat_interleave(x, n, dim=axis))(v_cache, rep, axis=1)
        scores = torch.einsum("bhqd,bhkd->bhqk", q, k) * (Dh ** -0.5)
        p = _softmax(scores, axis=-1)
        o = torch.einsum("bhqk,bhkd->bhqd", p, v)
        return (lambda x, *d: x.permute(*d))(o, 0, 2, 1, 3).reshape(B, Sq, Hq * Dh) @ wo

    def _B_ref(x, w1, b1, w2, b2):
        y = _layernorm(x, axis=-1)
        h = _gelu(torch.einsum("bsd,df->bsf", y, w1) + b1)
        return torch.einsum("bsf,fd->bsd", h, w2) + b2

    x = A_x
    h = x + _A_ref(_layernorm(x, axis=-1), A_k_cache, A_v_cache, A_wq, A_wo)
    h2 = h + _B_ref(_layernorm(h, axis=-1), B_w1, B_b1, B_w2, B_b2)
    return h2
```

```asm
; @launch grid=(256,1,1) block=(768,1,1) lds=158464
.amdgcn_target "amdgcn-amd-amdhsa--gfx950"
.text
.globl sequential_preLN__gqa_block_cached__mixer_channel_mlp__decode_kernel
.p2align 8
.type sequential_preLN__gqa_block_cached__mixer_channel_mlp__decode_kernel,@function
sequential_preLN__gqa_block_cached__mixer_channel_mlp__decode_kernel:
  s_cmp_ge_u32 s2, 256
  s_cbranch_scc1 L_exit
  s_mov_b64 s[4:5], -1
  s_load_dwordx16 s[8:23], s[0:1], 0
  s_load_dwordx8 s[24:31], s[0:1], 64
  s_load_dwordx2 s[32:33], s[0:1], 96
  v_lshrrev_b32 v1, 6, v0
  v_and_b32 v0, 63, v0
  v_readfirstlane_b32 s3, v1
  s_and_b32 s34, s2, 7
  s_lshr_b32 s35, s2, 3
  s_lshr_b32 s36, s35, 3
  s_and_b32 s37, s35, 7
  v_lshrrev_b32 v2, 4, v0
  v_and_b32 v3, 15, v0
  s_cmp_lt_u32 s3, 4
  s_cbranch_scc1 L_chain
  s_sub_u32 s44, s3, 4
  s_lshl_b32 s45, s36, 3
  s_add_u32 s45, s45, s34
  s_lshl_b32 s45, s45, 20
  s_lshl_b32 s46, s37, 17
  s_add_u32 s45, s45, s46
  s_lshl_b32 s47, s44, 14
  s_add_u32 s45, s45, s47
  v_add_u32 v8, 0, v2
  v_xor_b32 v8, v8, v3
  v_lshlrev_b32 v8, 4, v8
  v_lshl_add_u32 v4, v2, 8, v8
  v_add_u32 v8, 4, v2
  v_xor_b32 v8, v8, v3
  v_lshlrev_b32 v8, 4, v8
  v_lshl_add_u32 v5, v2, 8, v8
  v_add_u32 v8, 8, v2
  v_xor_b32 v8, v8, v3
  v_lshlrev_b32 v8, 4, v8
  v_lshl_add_u32 v6, v2, 8, v8
  v_add_u32 v8, 12, v2
  v_xor_b32 v8, v8, v3
  v_lshlrev_b32 v8, 4, v8
  v_lshl_add_u32 v7, v2, 8, v8
  v_lshlrev_b32 v8, 4, v3
  v_lshl_add_u32 v9, v2, 10, v8
  s_mov_b32 m0, s47
  s_mov_b32 s52, s47
  v_mov_b32 v93, 151680
  v_mov_b32 v94, 1
  s_waitcnt lgkmcnt(0)
  s_add_u32 s56, s10, s45
  s_addc_u32 s57, s11, 0
  s_add_u32 s58, s12, s45
  s_addc_u32 s59, s13, 0
  s_add_u32 s55, s44, 0
  s_and_b32 s55, s55, 3
  s_lshl_b32 s55, s55, 12
  s_add_u32 s48, s56, s55
  s_addc_u32 s49, s57, 0
  s_barrier
  global_load_lds_dwordx4 v4, s[48:49] offset:0 nt
  global_load_lds_dwordx4 v5, s[48:49] offset:1024 nt
  global_load_lds_dwordx4 v6, s[48:49] offset:2048 nt
  s_waitcnt vmcnt(2)
  global_load_lds_dwordx4 v7, s[48:49] offset:3072 nt
  s_waitcnt vmcnt(2)
  s_add_u32 s55, s44, 1
  s_and_b32 s55, s55, 3
  s_lshl_b32 s55, s55, 12
  s_add_u32 s48, s56, s55
  s_addc_u32 s49, s57, 0
  s_add_u32 s52, s52, 4096
  s_mov_b32 m0, s52
  s_nop 0
  global_load_lds_dwordx4 v4, s[48:49] offset:0 nt
  s_waitcnt vmcnt(2)
  global_load_lds_dwordx4 v5, s[48:49] offset:1024 nt
  s_waitcnt vmcnt(2)
  global_load_lds_dwordx4 v6, s[48:49] offset:2048 nt
  s_waitcnt vmcnt(2)
  global_load_lds_dwordx4 v7, s[48:49] offset:3072 nt
  s_waitcnt vmcnt(2)
  s_add_u32 s55, s44, 2
  s_and_b32 s55, s55, 3
  s_lshl_b32 s55, s55, 12
  s_add_u32 s48, s56, s55
  s_addc_u32 s49, s57, 0
  s_add_u32 s52, s52, 4096
  s_mov_b32 m0, s52
  s_nop 0
  global_load_lds_dwordx4 v4, s[48:49] offset:0 nt
  s_waitcnt vmcnt(2)
  global_load_lds_dwordx4 v5, s[48:49] offset:1024 nt
  s_waitcnt vmcnt(2)
  global_load_lds_dwordx4 v6, s[48:49] offset:2048 nt
  s_waitcnt vmcnt(2)
  global_load_lds_dwordx4 v7, s[48:49] offset:3072 nt
  s_waitcnt vmcnt(2)
  s_add_u32 s55, s44, 3
  s_and_b32 s55, s55, 3
  s_lshl_b32 s55, s55, 12
  s_add_u32 s48, s56, s55
  s_addc_u32 s49, s57, 0
  s_add_u32 s52, s52, 4096
  s_mov_b32 m0, s52
  s_nop 0
  global_load_lds_dwordx4 v4, s[48:49] offset:0 nt
  s_waitcnt vmcnt(2)
  global_load_lds_dwordx4 v5, s[48:49] offset:1024 nt
  s_waitcnt vmcnt(2)
  global_load_lds_dwordx4 v6, s[48:49] offset:2048 nt
  s_waitcnt vmcnt(2)
  global_load_lds_dwordx4 v7, s[48:49] offset:3072 nt
  s_waitcnt vmcnt(2)
  s_mov_b64 exec, 1
  ds_add_u32 v93, v94 offset:4
  s_mov_b64 exec, -1
  s_mov_b32 s61, 100000
L_poll_1:
  ds_read_b32 v8, v93 offset:4
  ds_read_b32 v10, v93 offset:16
  s_waitcnt lgkmcnt(0)
  v_xor_b32 v8, 8, v8
  v_xor_b32 v10, 1, v10
  v_or_b32 v8, v8, v10
  v_cmp_ne_u32 vcc, 0, v8
  s_cbranch_vccz L_pdone_2
  s_sub_u32 s61, s61, 1
  s_cbranch_scc1 L_pdone_2
  s_sleep 1
  s_branch L_poll_1
L_pdone_2:
  s_add_u32 s55, s44, 0
  s_and_b32 s55, s55, 3
  s_lshl_b32 s55, s55, 12
  s_add_u32 s50, s58, s55
  s_addc_u32 s51, s59, 0
  global_load_dwordx4 v[96:99], v9, s[50:51] offset:0 nt
  global_load_dwordx4 v[100:103], v9, s[50:51] offset:256 nt
  global_load_dwordx4 v[104:107], v9, s[50:51] offset:512 nt
  global_load_dwordx4 v[108:111], v9, s[50:51] offset:768 nt
  s_add_u32 s55, s44, 1
  s_and_b32 s55, s55, 3
  s_lshl_b32 s55, s55, 12
  s_add_u32 s50, s58, s55
  s_addc_u32 s51, s59, 0
  global_load_dwordx4 v[112:115], v9, s[50:51] offset:0 nt
  global_load_dwordx4 v[116:119], v9, s[50:51] offset:256 nt
  global_load_dwordx4 v[120:123], v9, s[50:51] offset:512 nt
  global_load_dwordx4 v[124:127], v9, s[50:51] offset:768 nt
  s_add_u32 s55, s44, 2
  s_and_b32 s55, s55, 3
  s_lshl_b32 s55, s55, 12
  s_add_u32 s50, s58, s55
  s_addc_u32 s51, s59, 0
  global_load_dwordx4 v[128:131], v9, s[50:51] offset:0 nt
  global_load_dwordx4 v[132:135], v9, s[50:51] offset:256 nt
  global_load_dwordx4 v[136:139], v9, s[50:51] offset:512 nt
  global_load_dwordx4 v[140:143], v9, s[50:51] offset:768 nt
  s_sub_u32 s56, s37, s34
  s_sub_u32 s56, s56, 1
  s_and_b32 s56, s56, 7
  s_lshl_b32 s57, s36, 3
  s_add_u32 s57, s57, s34
  s_lshl_b32 s41, s57, 1
  s_add_u32 s41, s41, s56
  s_cmp_lt_u32 s56, 2
  s_cselect_b32 s40, 1, 0
  s_lshr_b32 s63, s56, 1
  s_cmp_eq_u32 s63, 1
  s_cselect_b32 s63, 1, 0
  s_cmp_ge_u32 s56, 6
  s_cselect_b32 s39, 1, 0
  s_lshl_b32 s6, s34, 1
  s_and_b32 s7, s56, 1
  s_add_u32 s6, s6, s7
  s_cmp_lt_u32 s57, 28
  s_cselect_b32 s40, s40, 0
  s_cselect_b32 s63, s63, 0
  v_add_u32 v8, 0, v2
  v_xor_b32 v8, v8, v3
  v_lshlrev_b32 v8, 4, v8
  v_lshl_add_u32 v8, v3, 8, v8
  v_add_u32 v10, s47, v8
  v_add_u32 v8, 4, v2
  v_xor_b32 v8, v8, v3
  v_lshlrev_b32 v8, 4, v8
  v_lshl_add_u32 v8, v3, 8, v8
  v_add_u32 v11, s47, v8
  v_add_u32 v8, 8, v2
  v_xor_b32 v8, v8, v3
  v_lshlrev_b32 v8, 4, v8
  v_lshl_add_u32 v8, v3, 8, v8
  v_add_u32 v12, s47, v8
  v_add_u32 v8, 12, v2
  v_xor_b32 v8, v8, v3
  v_lshlrev_b32 v8, 4, v8
  v_lshl_add_u32 v8, v3, 8, v8
  v_add_u32 v13, s47, v8
  v_lshrrev_b32 v8, 2, v3
  v_lshlrev_b32 v14, 8, v8
  v_lshl_add_u32 v14, v2, 4, v14
  v_add_u32 v14, 155840, v14
  v_lshlrev_b32 v15, 5, v8
  v_add_u32 v15, 156864, v15
  v_lshlrev_b32 v88, 5, v8
  s_lshl_b32 s55, s44, 2
  s_add_u32 s55, s55, 151552
  v_add_u32 v88, s55, v88
  v_and_b32 v8, 1, v3
  v_lshlrev_b32 v8, 4, v8
  v_mov_b32 v91, 0xffff
  v_lshlrev_b32 v91, v8, v91
  v_and_b32 v8, 3, v3
  v_cmp_gt_u32 vcc, 2, v8
  v_lshlrev_b32 v92, 4, v0
  s_add_u32 s55, s47, 8192
  v_add_u32 v92, s55, v92
  v_cndmask_b32 v89, 0, v91, vcc
  v_cndmask_b32 v90, v91, 0, vcc
  s_mov_b32 s53, 0x3db504f3
  s_mov_b32 s54, 0x3fb8aa3b
  s_mov_b32 s61, 100000
L_poll_3:
  ds_read_b32 v8, v93 offset:0
  s_waitcnt lgkmcnt(0)
  v_cmp_ne_u32 vcc, 1, v8
  s_cbranch_vccz L_pdone_4
  s_sub_u32 s61, s61, 1
  s_cbranch_scc1 L_pdone_4
  s_sleep 1
  s_branch L_poll_3
L_pdone_4:
  ds_read_b128 v[16:19], v14 offset:0
  ds_read_b128 v[20:23], v14 offset:64
  ds_read_b128 v[24:27], v14 offset:128
  ds_read_b128 v[28:31], v14 offset:192
  s_waitcnt vmcnt(12)
  ds_read_b128 v[32:35], v10 offset:0
  ds_read_b128 v[36:39], v11 offset:0
  ds_read_b128 v[40:43], v12 offset:0
  ds_read_b128 v[44:47], v13 offset:0
  ds_read_b128 v[48:51], v10 offset:4096
  ds_read_b128 v[52:55], v11 offset:4096
  ds_read_b128 v[56:59], v12 offset:4096
  ds_read_b128 v[60:63], v13 offset:4096
  s_waitcnt lgkmcnt(4)
  v_mfma_f32_16x16x32_bf16 v[64:67], v[32:35], v[16:19], 0
  v_mfma_f32_16x16x32_bf16 v[64:67], v[36:39], v[20:23], v[64:67]
  v_mfma_f32_16x16x32_bf16 v[64:67], v[40:43], v[24:27], v[64:67]
  v_mfma_f32_16x16x32_bf16 v[64:67], v[44:47], v[28:31], v[64:67]
  ds_read_b128 v[32:35], v10 offset:8192
  ds_read_b128 v[36:39], v11 offset:8192
  ds_read_b128 v[40:43], v12 offset:8192
  ds_read_b128 v[44:47], v13 offset:8192
  s_waitcnt lgkmcnt(4)
  v_mfma_f32_16x16x32_bf16 v[68:71], v[48:51], v[16:19], 0
  v_mfma_f32_16x16x32_bf16 v[68:71], v[52:55], v[20:23], v[68:71]
  v_mfma_f32_16x16x32_bf16 v[68:71], v[56:59], v[24:27], v[68:71]
  v_mfma_f32_16x16x32_bf16 v[68:71], v[60:63], v[28:31], v[68:71]
  ds_read_b128 v[48:51], v10 offset:12288
  ds_read_b128 v[52:55], v11 offset:12288
  ds_read_b128 v[56:59], v12 offset:12288
  ds_read_b128 v[60:63], v13 offset:12288
  s_waitcnt lgkmcnt(4)
  v_mfma_f32_16x16x32_bf16 v[72:75], v[32:35], v[16:19], 0
  v_mfma_f32_16x16x32_bf16 v[72:75], v[36:39], v[20:23], v[72:75]
  v_mfma_f32_16x16x32_bf16 v[72:75], v[40:43], v[24:27], v[72:75]
  v_mfma_f32_16x16x32_bf16 v[72:75], v[44:47], v[28:31], v[72:75]
  s_waitcnt lgkmcnt(0)
  v_mfma_f32_16x16x32_bf16 v[76:79], v[48:51], v[16:19], 0
  v_mfma_f32_16x16x32_bf16 v[76:79], v[52:55], v[20:23], v[76:79]
  v_mfma_f32_16x16x32_bf16 v[76:79], v[56:59], v[24:27], v[76:79]
  v_mfma_f32_16x16x32_bf16 v[76:79], v[60:63], v[28:31], v[76:79]
  v_cvt_pk_bf16_f32 v8, v64, v65
  v_lshlrev_b32 v64, 16, v8
  v_and_b32 v65, 0xffff0000, v8
  v_mul_f32 v64, s53, v64
  v_mul_f32 v65, s53, v65
  v_cvt_pk_bf16_f32 v8, v64, v65
  v_lshlrev_b32 v64, 16, v8
  v_and_b32 v65, 0xffff0000, v8
  v_cvt_pk_bf16_f32 v8, v66, v67
  v_lshlrev_b32 v66, 16, v8
  v_and_b32 v67, 0xffff0000, v8
  v_mul_f32 v66, s53, v66
  v_mul_f32 v67, s53, v67
  v_cvt_pk_bf16_f32 v8, v66, v67
  v_lshlrev_b32 v66, 16, v8
  v_and_b32 v67, 0xffff0000, v8
  v_cvt_pk_bf16_f32 v8, v68, v69
  v_lshlrev_b32 v68, 16, v8
  v_and_b32 v69, 0xffff0000, v8
  v_mul_f32 v68, s53, v68
  v_mul_f32 v69, s53, v69
  v_cvt_pk_bf16_f32 v8, v68, v69
  v_lshlrev_b32 v68, 16, v8
  v_and_b32 v69, 0xffff0000, v8
  v_cvt_pk_bf16_f32 v8, v70, v71
  v_lshlrev_b32 v70, 16, v8
  v_and_b32 v71, 0xffff0000, v8
  v_mul_f32 v70, s53, v70
  v_mul_f32 v71, s53, v71
  v_cvt_pk_bf16_f32 v8, v70, v71
  v_lshlrev_b32 v70, 16, v8
  v_and_b32 v71, 0xffff0000, v8
  v_cvt_pk_bf16_f32 v8, v72, v73
  v_lshlrev_b32 v72, 16, v8
  v_and_b32 v73, 0xffff0000, v8
  v_mul_f32 v72, s53, v72
  v_mul_f32 v73, s53, v73
  v_cvt_pk_bf16_f32 v8, v72, v73
  v_lshlrev_b32 v72, 16, v8
  v_and_b32 v73, 0xffff0000, v8
  v_cvt_pk_bf16_f32 v8, v74, v75
  v_lshlrev_b32 v74, 16, v8
  v_and_b32 v75, 0xffff0000, v8
  v_mul_f32 v74, s53, v74
  v_mul_f32 v75, s53, v75
  v_cvt_pk_bf16_f32 v8, v74, v75
  v_lshlrev_b32 v74, 16, v8
  v_and_b32 v75, 0xffff0000, v8
  v_cvt_pk_bf16_f32 v8, v76, v77
  v_lshlrev_b32 v76, 16, v8
  v_and_b32 v77, 0xffff0000, v8
  v_mul_f32 v76, s53, v76
  v_mul_f32 v77, s53, v77
  v_cvt_pk_bf16_f32 v8, v76, v77
  v_lshlrev_b32 v76, 16, v8
  v_and_b32 v77, 0xffff0000, v8
  v_cvt_pk_bf16_f32 v8, v78, v79
  v_lshlrev_b32 v78, 16, v8
  v_and_b32 v79, 0xffff0000, v8
  v_mul_f32 v78, s53, v78
  v_mul_f32 v79, s53, v79
  v_cvt_pk_bf16_f32 v8, v78, v79
  v_lshlrev_b32 v78, 16, v8
  v_and_b32 v79, 0xffff0000, v8
  v_max3_f32 v8, v64, v65, v66
  v_max3_f32 v8, v8, v67, v68
  v_max3_f32 v8, v8, v69, v70
  v_max3_f32 v8, v8, v71, v72
  v_max3_f32 v8, v8, v73, v74
  v_max3_f32 v8, v8, v75, v76
  v_max3_f32 v8, v8, v77, v78
  v_max_f32 v8, v8, v79
  v_mov_b32 v95, v8
  s_nop 1
  v_permlane16_swap_b32 v8, v95
  s_nop 0
  v_max_f32 v8, v8, v95
  v_mov_b32 v95, v8
  s_nop 1
  v_permlane32_swap_b32 v8, v95
  s_nop 0
  v_max_f32 v8, v8, v95
  s_lshl_b32 s55, s44, 2
  v_add_u32 v95, s55, v15
  s_mov_b32 exec_lo, 0x1111
  s_mov_b32 exec_hi, 0
  ds_write_b32 v95, v8
  s_mov_b64 exec, 1
  ds_add_u32 v93, v94 offset:36
  s_mov_b64 exec, -1
  v_mul_f32 v95, s54, v8
  v_fma_f32 v64, v64, s54, -v95
  v_fma_f32 v65, v65, s54, -v95
  v_fma_f32 v66, v66, s54, -v95
  v_fma_f32 v67, v67, s54, -v95
  v_fma_f32 v68, v68, s54, -v95
  v_fma_f32 v69, v69, s54, -v95
  v_fma_f32 v70, v70, s54, -v95
  v_fma_f32 v71, v71, s54, -v95
  v_fma_f32 v72, v72, s54, -v95
  v_fma_f32 v73, v73, s54, -v95
  v_fma_f32 v74, v74, s54, -v95
  v_fma_f32 v75, v75, s54, -v95
  v_fma_f32 v76, v76, s54, -v95
  v_fma_f32 v77, v77, s54, -v95
  v_fma_f32 v78, v78, s54, -v95
  v_fma_f32 v79, v79, s54, -v95
  v_exp_f32 v64, v64
  v_exp_f32 v65, v65
  v_exp_f32 v66, v66
  v_exp_f32 v67, v67
  v_exp_f32 v68, v68
  v_exp_f32 v69, v69
  v_exp_f32 v70, v70
  v_exp_f32 v71, v71
  v_exp_f32 v72, v72
  v_exp_f32 v73, v73
  v_exp_f32 v74, v74
  v_exp_f32 v75, v75
  v_exp_f32 v76, v76
  v_exp_f32 v77, v77
  v_exp_f32 v78, v78
  v_exp_f32 v79, v79
  s_nop 0
  v_add_f32 v8, v64, v65
  v_add_f32 v87, v66, v67
  v_add_f32 v8, v8, v68
  v_add_f32 v87, v87, v69
  v_add_f32 v8, v8, v70
  v_add_f32 v87, v87, v71
  v_add_f32 v8, v8, v72
  v_add_f32 v87, v87, v73
  v_add_f32 v8, v8, v74
  v_add_f32 v87, v87, v75
  v_add_f32 v8, v8, v76
  v_add_f32 v87, v87, v77
  v_add_f32 v8, v8, v78
  v_add_f32 v87, v87, v79
  v_add_f32 v8, v8, v87
  v_cvt_pk_bf16_f32 v64, v64, v64
  v_cvt_pk_bf16_f32 v65, v65, v65
  v_cvt_pk_bf16_f32 v66, v66, v66
  v_cvt_pk_bf16_f32 v67, v67, v67
  v_cvt_pk_bf16_f32 v68, v68, v68
  v_cvt_pk_bf16_f32 v69, v69, v69
  v_cvt_pk_bf16_f32 v70, v70, v70
  v_cvt_pk_bf16_f32 v71, v71, v71
  v_cvt_pk_bf16_f32 v72, v72, v72
  v_cvt_pk_bf16_f32 v73, v73, v73
  v_cvt_pk_bf16_f32 v74, v74, v74
  v_cvt_pk_bf16_f32 v75, v75, v75
  v_cvt_pk_bf16_f32 v76, v76, v76
  v_cvt_pk_bf16_f32 v77, v77, v77
  v_cvt_pk_bf16_f32 v78, v78, v78
  v_cvt_pk_bf16_f32 v79, v79, v79
  v_mov_b32 v87, v8
  s_nop 1
  v_permlane16_swap_b32 v8, v87
  s_nop 0
  v_add_f32 v8, v8, v87
  v_mov_b32 v87, v8
  s_nop 1
  v_permlane32_swap_b32 v8, v87
  s_nop 0
  v_add_f32 v8, v8, v87
  v_mov_b32 v16, v8
  s_add_u32 s55, s44, 3
  s_and_b32 s55, s55, 3
  s_lshl_b32 s55, s55, 12
  s_add_u32 s50, s58, s55
  s_addc_u32 s51, s59, 0
  global_load_dwordx4 v[144:147], v9, s[50:51] offset:0 nt
  global_load_dwordx4 v[148:151], v9, s[50:51] offset:256 nt
  global_load_dwordx4 v[152:155], v9, s[50:51] offset:512 nt
  global_load_dwordx4 v[156:159], v9, s[50:51] offset:768 nt
  s_mov_b64 exec, 1
  ds_add_u32 v93, v94 offset:8
  s_mov_b64 exec, -1
  s_mov_b32 s61, 100000
L_poll_5:
  ds_read_b32 v8, v93 offset:36
  s_waitcnt lgkmcnt(0)
  v_cmp_ne_u32 vcc, 8, v8
  s_cbranch_vccz L_pdone_6
  s_sub_u32 s61, s61, 1
  s_cbranch_scc1 L_pdone_6
  s_sleep 1
  s_branch L_poll_5
L_pdone_6:
  ds_read_b128 v[32:35], v15
  ds_read_b128 v[36:39], v15 offset:16
  s_waitcnt lgkmcnt(0)
  v_max3_f32 v8, v32, v33, v34
  v_max3_f32 v8, v8, v35, v36
  v_max3_f32 v8, v8, v37, v38
  v_max_f32 v8, v8, v39
  v_fma_f32 v17, -v8, s54, v95
  v_exp_f32 v17, v17
  s_nop 0
  v_mul_f32 v16, v16, v17
  s_mov_b32 exec_lo, 0x1111
  s_mov_b32 exec_hi, 0
  ds_write_b32 v88, v16
  s_mov_b64 exec, -1
  v_and_b32 v32, v64, v89
  v_and_b32 v33, v64, v90
  s_waitcnt vmcnt(15)
  s_nop 0
  v_mfma_f32_16x16x16_bf16 v[80:83], v[96:97], v[32:33], 0
  v_mfma_f32_16x16x16_bf16 v[84:87], v[98:99], v[32:33], 0
  v_and_b32 v34, v65, v89
  v_and_b32 v35, v65, v90
  s_waitcnt vmcnt(14)
  s_nop 0
  v_mfma_f32_16x16x16_bf16 v[80:83], v[100:101], v[34:35], v[80:83]
  v_mfma_f32_16x16x16_bf16 v[84:87], v[102:103], v[34:35], v[84:87]
  v_and_b32 v36, v66, v89
  v_and_b32 v37, v66, v90
  s_waitcnt vmcnt(13)
  s_nop 0
  v_mfma_f32_16x16x16_bf16 v[80:83], v[104:105], v[36:37], v[80:83]
  v_mfma_f32_16x16x16_bf16 v[84:87], v[106:107], v[36:37], v[84:87]
  v_and_b32 v38, v67, v89
  v_and_b32 v39, v67, v90
  s_waitcnt vmcnt(12)
  s_nop 0
  v_mfma_f32_16x16x16_bf16 v[80:83], v[108:109], v[38:39], v[80:83]
  v_mfma_f32_16x16x16_bf16 v[84:87], v[110:111], v[38:39], v[84:87]
  v_and_b32 v32, v68, v89
  v_and_b32 v33, v68, v90
  s_waitcnt vmcnt(11)
  s_nop 0
  v_mfma_f32_16x16x16_bf16 v[80:83], v[112:113], v[32:33], v[80:83]
  v_mfma_f32_16x16x16_bf16 v[84:87], v[114:115], v[32:33], v[84:87]
  v_and_b32 v34, v69, v89
  v_and_b32 v35, v69, v90
  s_waitcnt vmcnt(10)
  s_nop 0
  v_mfma_f32_16x16x16_bf16 v[80:83], v[116:117], v[34:35], v[80:83]
  v_mfma_f32_16x16x16_bf16 v[84:87], v[118:119], v[34:35], v[84:87]
  v_and_b32 v36, v70, v89
  v_and_b32 v37, v70, v90
  s_waitcnt vmcnt(9)
  s_nop 0
  v_mfma_f32_16x16x16_bf16 v[80:83], v[120:121], v[36:37], v[80:83]
  v_mfma_f32_16x16x16_bf16 v[84:87], v[122:123], v[36:37], v[84:87]
  v_and_b32 v38, v71, v89
  v_and_b32 v39, v71, v90
  s_waitcnt vmcnt(8)
  s_nop 0
  v_mfma_f32_16x16x16_bf16 v[80:83], v[124:125], v[38:39], v[80:83]
  v_mfma_f32_16x16x16_bf16 v[84:87], v[126:127], v[38:39], v[84:87]
  v_and_b32 v32, v72, v89
  v_and_b32 v33, v72, v90
  s_waitcnt vmcnt(7)
  s_nop 0
  v_mfma_f32_16x16x16_bf16 v[80:83], v[128:129], v[32:33], v[80:83]
  v_mfma_f32_16x16x16_bf16 v[84:87], v[130:131], v[32:33], v[84:87]
  v_and_b32 v34, v73, v89
  v_and_b32 v35, v73, v90
  s_waitcnt vmcnt(6)
  s_nop 0
  v_mfma_f32_16x16x16_bf16 v[80:83], v[132:133], v[34:35], v[80:83]
  v_mfma_f32_16x16x16_bf16 v[84:87], v[134:135], v[34:35], v[84:87]
  v_and_b32 v36, v74, v89
  v_and_b32 v37, v74, v90
  s_waitcnt vmcnt(5)
  s_nop 0
  v_mfma_f32_16x16x16_bf16 v[80:83], v[136:137], v[36:37], v[80:83]
  v_mfma_f32_16x16x16_bf16 v[84:87], v[138:139], v[36:37], v[84:87]
  v_and_b32 v38, v75, v89
  v_and_b32 v39, v75, v90
  s_waitcnt vmcnt(4)
  s_nop 0
  v_mfma_f32_16x16x16_bf16 v[80:83], v[140:141], v[38:39], v[80:83]
  v_mfma_f32_16x16x16_bf16 v[84:87], v[142:143], v[38:39], v[84:87]
  v_and_b32 v32, v76, v89
  v_and_b32 v33, v76, v90
  s_waitcnt vmcnt(3)
  s_nop 0
  v_mfma_f32_16x16x16_bf16 v[80:83], v[144:145], v[32:33], v[80:83]
  v_mfma_f32_16x16x16_bf16 v[84:87], v[146:147], v[32:33], v[84:87]
  v_and_b32 v34, v77, v89
  v_and_b32 v35, v77, v90
  s_waitcnt vmcnt(2)
  s_nop 0
  v_mfma_f32_16x16x16_bf16 v[80:83], v[148:149], v[34:35], v[80:83]
  v_mfma_f32_16x16x16_bf16 v[84:87], v[150:151], v[34:35], v[84:87]
  v_and_b32 v36, v78, v89
  v_and_b32 v37, v78, v90
  s_waitcnt vmcnt(1)
  s_nop 0
  v_mfma_f32_16x16x16_bf16 v[80:83], v[152:153], v[36:37], v[80:83]
  v_mfma_f32_16x16x16_bf16 v[84:87], v[154:155], v[36:37], v[84:87]
  v_and_b32 v38, v79, v89
  v_and_b32 v39, v79, v90
  s_waitcnt vmcnt(0)
  s_nop 0
  v_mfma_f32_16x16x16_bf16 v[80:83], v[156:157], v[38:39], v[80:83]
  v_mfma_f32_16x16x16_bf16 v[84:87], v[158:159], v[38:39], v[84:87]
  s_nop 6
  v_mul_f32 v80, v80, v17
  v_mul_f32 v81, v81, v17
  v_mul_f32 v82, v82, v17
  v_mul_f32 v83, v83, v17
  v_mul_f32 v84, v84, v17
  v_mul_f32 v85, v85, v17
  v_mul_f32 v86, v86, v17
  v_mul_f32 v87, v87, v17
  ds_write_b128 v92, v[80:83]
  ds_write_b128 v92, v[84:87] offset:1024
  s_mov_b64 exec, 1
  ds_add_u32 v93, v94 offset:24
  s_mov_b64 exec, -1
  s_cmp_lg_u32 s40, 0
  s_cbranch_scc1 L_s_D
  s_cmp_eq_u32 s39, 0
  s_cbranch_scc1 L_stream_end
  s_lshl_b32 s45, s36, 4
  s_add_u32 s45, s45, s6
  s_mul_i32 s45, s45, 7168
  s_lshl_b32 s46, s44, 10
  s_add_u32 s45, s45, s46
  s_add_u32 s45, s45, 1376256
  v_lshlrev_b32 v6, 4, v0
  v_add_u32 v6, s45, v6
  v_and_b32 v7, 7, v0
  v_lshlrev_b32 v7, 4, v7
  s_lshl_b32 s45, s44, 7
  s_add_u32 s45, s45, 148480
  v_add_u32 v7, s45, v7
  s_barrier
  s_barrier
  s_cmp_eq_u32 s44, 7
  s_cbranch_scc1 L_s_e1
  s_mov_b32 s60, 100000
L_p1_7:
  global_load_dwordx4 v[16:19], v6, s[32:33] sc1
  s_waitcnt vmcnt(0)
  v_cmp_eq_u32 vcc, -1, v19
  s_cbranch_vccz L_p1d_8
  s_mov_b64 exec, vcc
  s_sub_u32 s60, s60, 1
  s_cbranch_scc0 L_p1_7
L_p1d_8:
  s_mov_b64 exec, -1
  v_add_f32_dpp v16, v16, v16 row_ror:8 row_mask:0xf bank_mask:0xf
  v_add_f32_dpp v17, v17, v17 row_ror:8 row_mask:0xf bank_mask:0xf
  v_add_f32_dpp v18, v18, v18 row_ror:8 row_mask:0xf bank_mask:0xf
  v_add_f32_dpp v19, v19, v19 row_ror:8 row_mask:0xf bank_mask:0xf
  v_mov_b32 v24, v16
  v_mov_b32 v25, v17
  v_mov_b32 v26, v18
  v_mov_b32 v27, v19
  v_permlane16_swap_b32 v16, v24
  v_permlane16_swap_b32 v17, v25
  v_permlane16_swap_b32 v18, v26
  v_permlane16_swap_b32 v19, v27
  v_add_f32 v16, v16, v24
  v_add_f32 v17, v17, v25
  v_add_f32 v18, v18, v26
  v_add_f32 v19, v19, v27
  v_mov_b32 v24, v16
  v_mov_b32 v25, v17
  v_mov_b32 v26, v18
  v_mov_b32 v27, v19
  v_permlane32_swap_b32 v16, v24
  v_permlane32_swap_b32 v17, v25
  v_permlane32_swap_b32 v18, v26
  v_permlane32_swap_b32 v19, v27
  v_add_f32 v16, v16, v24
  v_add_f32 v17, v17, v25
  v_add_f32 v18, v18, v26
  v_add_f32 v19, v19, v27
  s_mov_b64 exec, 0xff
  ds_write_b128 v7, v[16:19]
  s_mov_b64 exec, -1
  s_waitcnt lgkmcnt(0)
L_s_e1:
  s_barrier
  s_branch L_stream_end
L_s_D:
  v_mov_b32 v90, 151680
  v_lshrrev_b32 v8, 2, v3
  v_lshl_add_u32 v8, v2, 3, v8
  v_and_b32 v93, 3, v3
  v_lshlrev_b32 v93, 3, v93
  v_lshl_add_u32 v4, v8, 6, v93
  v_add_u32 v4, s47, v4
  v_lshlrev_b32 v5, 2, v93
  v_lshl_add_u32 v5, v8, 7, v5
  v_add_u32 v5, s47, v5
  v_and_b32 v6, 3, v3
  v_lshlrev_b32 v6, 10, v6
  v_lshl_add_u32 v6, v2, 4, v6
  s_lshl_b32 s58, s44, 7
  s_add_u32 s58, s58, 151744
  v_add_u32 v6, s58, v6
  v_lshlrev_b32 v7, 2, v0
  s_lshl_b32 s58, s44, 8
  s_add_u32 s58, s58, 147456
  v_add_u32 v7, s58, v7
  v_lshlrev_b32 v11, 2, v0
  s_lshl_b32 s58, s44, 11
  s_add_u32 s58, s58, 147456
  v_add_u32 v11, s58, v11
  v_lshrrev_b32 v10, 2, v3
  v_lshlrev_b32 v10, 6, v10
  v_lshl_add_u32 v10, v2, 4, v10
  v_add_u32 v10, 158016, v10
  v_mov_b32 v92, 158400
  v_and_b32 v91, 3, v3
  v_cmp_eq_u32 vcc, 0, v91
  s_nop 1
  v_cndmask_b32 v94, v92, v10, vcc
  v_cmp_eq_u32 vcc, 1, v91
  s_nop 1
  v_cndmask_b32 v95, v92, v10, vcc
  v_cmp_eq_u32 vcc, 2, v91
  s_nop 1
  v_cndmask_b32 v96, v92, v10, vcc
  v_cmp_eq_u32 vcc, 3, v91
  s_nop 1
  v_cndmask_b32 v97, v92, v10, vcc
  v_mov_b32 v24, 0
  v_mov_b32 v25, 0
  v_mov_b32 v26, 0
  v_mov_b32 v27, 0
  ds_write_b128 v92, v[24:27]
  v_lshrrev_b32 v15, 2, v3
  v_cmp_eq_u32 s[56:57], 1, v15
  v_cmp_eq_u32 s[58:59], 2, v15
  v_cmp_eq_u32 s[48:49], 3, v15
  v_lshrrev_b32 v12, 2, v3
  v_lshlrev_b32 v12, 4, v12
  v_lshrrev_b32 v24, 1, v2
  v_add_u32 v12, v12, v24
  v_mul_u32_u24 v12, 7168, v12
  v_and_b32 v24, 1, v2
  v_lshl_add_u32 v12, v24, 6, v12
  v_lshl_add_u32 v12, v91, 4, v12
  s_mul_i32 s45, s44, 14336
  s_lshl_b32 s46, s41, 7
  s_add_u32 s45, s45, s46
  s_add_u32 s45, s45, 1376256
  v_add_u32 v12, s45, v12
  v_lshlrev_b32 v13, 4, v0
  s_lshl_b32 s45, s44, 11
  s_lshl_b32 s46, s34, 13
  s_add_u32 s45, s45, s46
  s_add_u32 s45, s45, 1835008
  v_add_u32 v13, s45, v13
  v_lshlrev_b32 v14, 3, v0
  s_lshl_b32 s45, s44, 10
  s_add_u32 s45, s45, 151744
  v_add_u32 v14, s45, v14
  v_lshl_add_u32 v15, v2, 2, v15
  s_and_b32 s45, s44, 1
  s_lshl_b32 s45, s45, 4
  v_add_u32 v15, s45, v15
  v_lshlrev_b32 v9, 2, v15
  v_add_u32 v9, 158272, v9
  ds_read_b32 v88, v9
  v_and_b32 v9, 3, v3
  v_lshlrev_b32 v9, 6, v9
  v_lshl_add_u32 v9, v15, 1, v9
  v_add_u32 v9, 158016, v9
  v_mov_b32 v89, 0x3d372713
  s_mov_b32 s61, 100000
L_poll_9:
  ds_read_b32 v91, v90 offset:28
  s_waitcnt lgkmcnt(0)
  v_cmp_ne_u32 vcc, 4, v91
  s_cbranch_vccz L_pdone_10
  s_sub_u32 s61, s61, 1
  s_cbranch_scc1 L_pdone_10
  s_sleep 1
  s_branch L_poll_9
L_pdone_10:
  ds_read_b64_tr_b16 v[32:33], v4 offset:0
  ds_read_b64_tr_b16 v[34:35], v4 offset:256
  ds_read_b64_tr_b16 v[36:37], v4 offset:2048
  ds_read_b64_tr_b16 v[38:39], v4 offset:2304
  ds_read_b64_tr_b16 v[40:41], v4 offset:32
  ds_read_b64_tr_b16 v[42:43], v4 offset:288
  ds_read_b64_tr_b16 v[44:45], v4 offset:2080
  ds_read_b64_tr_b16 v[46:47], v4 offset:2336
  s_waitcnt lgkmcnt(0)
  ds_read_b64_tr_b16 v[48:49], v5 offset:4096
  ds_read_b64_tr_b16 v[50:51], v5 offset:4608
  ds_read_b64_tr_b16 v[52:53], v5 offset:4104
  ds_read_b64_tr_b16 v[54:55], v5 offset:4616
  ds_read_b64_tr_b16 v[56:57], v5 offset:4112
  ds_read_b64_tr_b16 v[58:59], v5 offset:4624
  ds_read_b64_tr_b16 v[60:61], v5 offset:4120
  ds_read_b64_tr_b16 v[62:63], v5 offset:4632
  s_waitcnt lgkmcnt(0)
  s_cmp_ge_u32 s44, 4
  s_cbranch_scc1 L_d1
  s_mov_b64 s[88:89], -1
  s_mov_b64 s[90:91], -1
  s_mov_b32 s60, 100000
L_hop_11:
  s_mov_b64 exec, s[88:89]
  s_cbranch_execz L_sk_13
  global_load_dwordx4 v[100:103], v13, s[32:33] sc1
L_sk_13:
  s_mov_b64 exec, s[90:91]
  s_cbranch_execz L_sk_14
  global_load_dwordx4 v[104:107], v13, s[32:33] offset:1024 sc1
L_sk_14:
  s_waitcnt vmcnt(0)
  s_mov_b64 exec, s[88:89]
  v_cmp_eq_u32 s[88:89], -1, v103
  s_mov_b64 exec, s[90:91]
  v_cmp_eq_u32 s[90:91], -1, v107
  s_or_b64 vcc, s[88:89], s[90:91]
  s_cbranch_scc0 L_hopdone_12
  s_sub_u32 s60, s60, 1
  s_cbranch_scc0 L_hop_11
L_hopdone_12:
  s_mov_b64 exec, -1
  v_add_f32 v24, v100, v101
  v_add_f32 v25, v102, v103
  v_add_f32 v26, v104, v105
  v_add_f32 v27, v106, v107
  v_add_f32 v24, v24, v25
  v_add_f32 v26, v26, v27
  v_add_f32 v24, v24, v26
  s_nop 1
  v_add_f32_dpp v24, v24, v24 row_ror:8 row_mask:0xf bank_mask:0xf
  s_nop 1
  v_add_f32_dpp v24, v24, v24 row_ror:4 row_mask:0xf bank_mask:0xf
  s_nop 1
  v_add_f32_dpp v24, v24, v24 row_ror:2 row_mask:0xf bank_mask:0xf
  s_nop 1
  v_add_f32_dpp v24, v24, v24 row_ror:1 row_mask:0xf bank_mask:0xf
  v_mov_b32 v25, v24
  s_nop 1
  v_permlane16_swap_b32 v24, v25
  s_nop 0
  v_add_f32 v24, v24, v25
  v_mov_b32 v25, v24
  s_nop 1
  v_permlane32_swap_b32 v24, v25
  s_nop 0
  v_add_f32 v24, v24, v25
  v_mul_f32 v24, 0x3b000000, v24
  v_sub_f32 v16, v100, v24
  v_sub_f32 v17, v101, v24
  v_sub_f32 v18, v102, v24
  v_sub_f32 v19, v103, v24
  v_sub_f32 v20, v104, v24
  v_sub_f32 v21, v105, v24
  v_sub_f32 v22, v106, v24
  v_sub_f32 v23, v107, v24
  v_mul_f32 v25, v16, v16
  v_mul_f32 v26, v17, v17
  v_fma_f32 v25, v18, v18, v25
  v_fma_f32 v26, v19, v19, v26
  v_fma_f32 v25, v20, v20, v25
  v_fma_f32 v26, v21, v21, v26
  v_fma_f32 v25, v22, v22, v25
  v_fma_f32 v26, v23, v23, v26
  v_add_f32 v25, v25, v26
  s_nop 1
  v_add_f32_dpp v25, v25, v25 row_ror:8 row_mask:0xf bank_mask:0xf
  s_nop 1
  v_add_f32_dpp v25, v25, v25 row_ror:4 row_mask:0xf bank_mask:0xf
  s_nop 1
  v_add_f32_dpp v25, v25, v25 row_ror:2 row_mask:0xf bank_mask:0xf
  s_nop 1
  v_add_f32_dpp v25, v25, v25 row_ror:1 row_mask:0xf bank_mask:0xf
  v_mov_b32 v26, v25
  s_nop 1
  v_permlane16_swap_b32 v25, v26
  s_nop 0
  v_add_f32 v25, v25, v26
  v_mov_b32 v26, v25
  s_nop 1
  v_permlane32_swap_b32 v25, v26
  s_nop 0
  v_add_f32 v25, v25, v26
  v_mul_f32 v25, 0x3b000000, v25
  v_add_f32 v26, 0x3727c5ac, v25
  v_rcp_f32 v27, v26
  v_rsq_f32 v26, v26
  s_nop 0
  v_mul_f32 v27, v25, v27
  v_add_f32 v27, 0x3727c5ac, v27
  v_rsq_f32 v27, v27
  s_nop 0
  v_mul_f32 v26, v26, v27
  v_mul_f32 v16, v16, v26
  v_mul_f32 v17, v17, v26
  v_mul_f32 v18, v18, v26
  v_mul_f32 v19, v19, v26
  v_mul_f32 v20, v20, v26
  v_mul_f32 v21, v21, v26
  v_mul_f32 v22, v22, v26
  v_mul_f32 v23, v23, v26
  v_cvt_pk_bf16_f32 v72, v16, v17
  v_cvt_pk_bf16_f32 v73, v18, v19
  v_cvt_pk_bf16_f32 v74, v20, v21
  v_cvt_pk_bf16_f32 v75, v22, v23
  ds_write_b64 v14, v[72:73]
  ds_write_b64 v14, v[74:75] offset:512
  s_waitcnt lgkmcnt(0)
L_d1:
  s_barrier
  ds_read_b128 v[16:19], v6 offset:0
  ds_read_b128 v[20:23], v6 offset:64
  s_waitcnt lgkmcnt(1)
  v_mfma_f32_16x16x32_bf16 v[80:83], v[32:35], v[16:19], 0
  v_mfma_f32_16x16x32_bf16 v[84:87], v[40:43], v[16:19], 0
  s_waitcnt lgkmcnt(0)
  v_mfma_f32_16x16x32_bf16 v[80:83], v[36:39], v[20:23], v[80:83]
  v_mfma_f32_16x16x32_bf16 v[84:87], v[44:47], v[20:23], v[84:87]
  s_nop 6
  v_cndmask_b32 v80, v80, v81, s[56:57]
  v_cndmask_b32 v80, v80, v82, s[58:59]
  v_cndmask_b32 v80, v80, v83, s[48:49]
  v_cndmask_b32 v84, v84, v85, s[56:57]
  v_cndmask_b32 v84, v84, v86, s[58:59]
  v_cndmask_b32 v84, v84, v87, s[48:49]
  ds_write_b32 v7, v80
  ds_write_b32 v7, v84 offset:2048
  s_waitcnt lgkmcnt(0)
  s_barrier
  s_cmp_ge_u32 s44, 2
  s_cbranch_scc1 L_d3
  ds_read_b32 v16, v11 offset:0
  ds_read_b32 v17, v11 offset:256
  ds_read_b32 v18, v11 offset:512
  ds_read_b32 v19, v11 offset:768
  ds_read_b32 v20, v11 offset:1024
  ds_read_b32 v21, v11 offset:1280
  ds_read_b32 v22, v11 offset:1536
  ds_read_b32 v23, v11 offset:1792
  s_waitcnt lgkmcnt(0)
  v_add_f32 v16, v16, v17
  v_add_f32 v18, v18, v19
  v_add_f32 v20, v20, v21
  v_add_f32 v22, v22, v23
  v_add_f32 v16, v16, v18
  v_add_f32 v20, v20, v22
  v_add_f32 v18, v16, v20
  v_cvt_pk_bf16_f32 v18, v18, v18
  v_and_b32 v18, 0xffff0000, v18
  v_add_f32 v18, v18, v88
  v_cvt_pk_bf16_f32 v18, v18, v18
  v_and_b32 v18, 0xffff0000, v18
  v_mul_f32 v19, v18, v18
  v_fma_f32 v19, v19, v89, 1.0
  v_mul_f32 v19, v19, v18
  v_mul_f32 v19, 0xc0135761, v19
  v_exp_f32 v19, v19
  s_nop 0
  v_add_f32 v19, 1.0, v19
  v_rcp_f32 v19, v19
  s_nop 0
  v_mul_f32 v18, v18, v19
  v_cvt_pk_bf16_f32 v18, v18, v18
  ds_write_b16 v9, v18
  s_waitcnt lgkmcnt(0)
L_d3:
  s_barrier
  ds_read_b128 v[16:19], v94
  ds_read_b128 v[20:23], v95
  ds_read_b128 v[24:27], v96
  ds_read_b128 v[28:31], v97
  s_waitcnt lgkmcnt(3)
  v_mfma_f32_16x16x32_bf16 v[64:67], v[48:51], v[16:19], 0
  s_waitcnt lgkmcnt(2)
  v_mfma_f32_16x16x32_bf16 v[64:67], v[52:55], v[20:23], v[64:67]
  s_waitcnt lgkmcnt(1)
  v_mfma_f32_16x16x32_bf16 v[64:67], v[56:59], v[24:27], v[64:67]
  s_waitcnt lgkmcnt(0)
  v_mfma_f32_16x16x32_bf16 v[64:67], v[60:63], v[28:31], v[64:67]
  s_nop 7
  global_store_dwordx4 v12, v[64:67], s[32:33] sc1
L_stream_end:
  s_endpgm
L_chain:
  s_cmp_lg_u32 s3, 2
  s_cbranch_scc1 L_c_nz
  v_mov_b32 v8, 0
  v_mov_b32 v9, 0
  v_mov_b32 v10, 0
  v_mov_b32 v11, 0
  v_mov_b32 v7, 151680
  ds_write_b128 v7, v[8:11] offset:0
  ds_write_b128 v7, v[8:11] offset:16
  ds_write_b128 v7, v[8:11] offset:32
  ds_write_b128 v7, v[8:11] offset:48
L_c_nz:
  s_lshl_b32 s38, s34, 2
  s_add_u32 s38, s38, s36
  s_sub_u32 s56, s37, s34
  s_sub_u32 s56, s56, 1
  s_and_b32 s56, s56, 7
  s_lshl_b32 s57, s36, 3
  s_add_u32 s57, s57, s34
  s_lshl_b32 s41, s57, 1
  s_add_u32 s41, s41, s56
  s_cmp_lt_u32 s56, 2
  s_cselect_b32 s40, 1, 0
  s_lshr_b32 s63, s56, 1
  s_cmp_eq_u32 s63, 1
  s_cselect_b32 s63, 1, 0
  s_cmp_ge_u32 s56, 6
  s_cselect_b32 s39, 1, 0
  s_lshl_b32 s6, s34, 1
  s_and_b32 s7, s56, 1
  s_add_u32 s6, s6, s7
  s_cmp_lt_u32 s57, 28
  s_cselect_b32 s40, s40, 0
  s_cselect_b32 s63, s63, 0
  s_lshl_b32 s44, s34, 10
  s_lshl_b32 s45, s36, 6
  s_add_u32 s44, s44, s45
  s_and_b32 s45, s37, 1
  s_lshl_b32 s45, s45, 5
  s_add_u32 s44, s44, s45
  s_lshr_b32 s45, s37, 1
  s_lshl_b32 s45, s45, 3
  s_add_u32 s44, s44, s45
  s_add_u32 s44, s44, 8192
  v_and_b32 v102, 3, v0
  v_lshlrev_b32 v102, 8, v102
  v_add_u32 v102, s44, v102
  s_lshr_b32 s45, s35, 1
  s_and_b32 s45, s45, 3
  s_lshl_b32 s44, s34, 16
  s_lshl_b32 s46, s45, 12
  s_add_u32 s44, s44, s46
  s_lshl_b32 s46, s36, 10
  s_add_u32 s44, s44, s46
  s_and_b32 s46, s35, 1
  s_lshl_b32 s46, s46, 9
  s_add_u32 s44, s44, s46
  s_add_u32 s44, s44, 65536
  v_and_b32 v103, 3, v3
  v_lshlrev_b32 v103, 14, v103
  v_lshl_add_u32 v103, v2, 5, v103
  v_add_u32 v103, s44, v103
  v_mov_b32 v100, 151680
  v_mov_b32 v101, 1
  v_mov_b32 v126, 0
  s_waitcnt lgkmcnt(0)
  s_load_dword s62, s[32:33], 0
  s_cmp_eq_u32 s3, 0
  s_cbranch_scc1 L_c0
  s_barrier
  s_cmp_eq_u32 s3, 1
  s_cbranch_scc1 L_c1
  s_cmp_eq_u32 s3, 2
  s_cbranch_scc1 L_c2
  s_branch L_c3
L_c0:
  v_lshlrev_b32 v6, 10, v2
  v_lshl_add_u32 v7, v3, 6, v6
  global_load_dwordx4 v[16:19], v7, s[8:9] offset:0
  global_load_dwordx4 v[20:23], v7, s[8:9] offset:16
  global_load_dwordx4 v[24:27], v7, s[8:9] offset:32
  global_load_dwordx4 v[28:31], v7, s[8:9] offset:48
  s_lshl_b32 s46, s45, 8
  v_lshl_add_u32 v7, v3, 4, v6
  v_add_u32 v7, s46, v7
  global_load_dwordx4 v[12:15], v7, s[8:9]
  s_lshl_b32 s44, s45, 20
  s_lshl_b32 s46, s34, 10
  s_add_u32 s44, s44, s46
  s_lshl_b32 s46, s36, 8
  s_add_u32 s44, s44, s46
  s_and_b32 s46, s35, 1
  s_lshl_b32 s46, s46, 7
  s_add_u32 s44, s44, s46
  s_add_u32 s46, s14, s44
  s_addc_u32 s47, s15, 0
  v_lshrrev_b32 v7, 3, v0
  v_lshlrev_b32 v7, 13, v7
  v_and_b32 v8, 7, v0
  v_lshl_add_u32 v7, v8, 4, v7
  s_mov_b32 s48, 131072
  s_mov_b32 m0, s48
  s_add_u32 s48, s48, 1024
  global_load_lds_dwordx4 v7, s[46:47] nt
  s_add_u32 s46, s46, 0x10000
  s_addc_u32 s47, s47, 0
  s_mov_b32 m0, s48
  s_add_u32 s48, s48, 1024
  global_load_lds_dwordx4 v7, s[46:47] nt
  s_add_u32 s46, s46, 0x10000
  s_addc_u32 s47, s47, 0
  s_mov_b32 m0, s48
  s_add_u32 s48, s48, 1024
  global_load_lds_dwordx4 v7, s[46:47] nt
  s_add_u32 s46, s46, 0x10000
  s_addc_u32 s47, s47, 0
  s_mov_b32 m0, s48
  s_add_u32 s48, s48, 1024
  global_load_lds_dwordx4 v7, s[46:47] nt
  s_add_u32 s46, s46, 0x10000
  s_addc_u32 s47, s47, 0
  s_mov_b32 m0, s48
  s_add_u32 s48, s48, 1024
  global_load_lds_dwordx4 v7, s[46:47] nt
  s_add_u32 s46, s46, 0x10000
  s_addc_u32 s47, s47, 0
  s_mov_b32 m0, s48
  s_add_u32 s48, s48, 1024
  global_load_lds_dwordx4 v7, s[46:47] nt
  s_add_u32 s46, s46, 0x10000
  s_addc_u32 s47, s47, 0
  s_mov_b32 m0, s48
  s_add_u32 s48, s48, 1024
  global_load_lds_dwordx4 v7, s[46:47] nt
  s_add_u32 s46, s46, 0x10000
  s_addc_u32 s47, s47, 0
  s_mov_b32 m0, s48
  s_add_u32 s48, s48, 1024
  global_load_lds_dwordx4 v7, s[46:47] nt
  s_add_u32 s46, s46, 0x10000
  s_addc_u32 s47, s47, 0
  s_mov_b32 m0, s48
  s_add_u32 s48, s48, 1024
  global_load_lds_dwordx4 v7, s[46:47] nt
  s_add_u32 s46, s46, 0x10000
  s_addc_u32 s47, s47, 0
  s_mov_b32 m0, s48
  s_add_u32 s48, s48, 1024
  global_load_lds_dwordx4 v7, s[46:47] nt
  s_add_u32 s46, s46, 0x10000
  s_addc_u32 s47, s47, 0
  s_mov_b32 m0, s48
  s_add_u32 s48, s48, 1024
  global_load_lds_dwordx4 v7, s[46:47] nt
  s_add_u32 s46, s46, 0x10000
  s_addc_u32 s47, s47, 0
  s_mov_b32 m0, s48
  s_add_u32 s48, s48, 1024
  global_load_lds_dwordx4 v7, s[46:47] nt
  s_add_u32 s46, s46, 0x10000
  s_addc_u32 s47, s47, 0
  s_mov_b32 m0, s48
  s_add_u32 s48, s48, 1024
  global_load_lds_dwordx4 v7, s[46:47] nt
  s_add_u32 s46, s46, 0x10000
  s_addc_u32 s47, s47, 0
  s_mov_b32 m0, s48
  s_add_u32 s48, s48, 1024
  global_load_lds_dwordx4 v7, s[46:47] nt
  s_add_u32 s46, s46, 0x10000
  s_addc_u32 s47, s47, 0
  s_mov_b32 m0, s48
  s_add_u32 s48, s48, 1024
  global_load_lds_dwordx4 v7, s[46:47] nt
  s_add_u32 s46, s46, 0x10000
  s_addc_u32 s47, s47, 0
  s_mov_b32 m0, s48
  s_add_u32 s48, s48, 1024
  global_load_lds_dwordx4 v7, s[46:47] nt
  s_add_u32 s46, s46, 0x10000
  s_addc_u32 s47, s47, 0
  s_barrier
  s_waitcnt vmcnt(16)
  s_waitcnt lgkmcnt(0)
  s_not_b32 s43, s62
  s_add_u32 s42, s62, 1
  v_lshlrev_b32 v32, 16, v16
  v_and_b32 v33, 0xffff0000, v16
  v_lshlrev_b32 v34, 16, v17
  v_and_b32 v35, 0xffff0000, v17
  v_lshlrev_b32 v36, 16, v18
  v_and_b32 v37, 0xffff0000, v18
  v_lshlrev_b32 v38, 16, v19
  v_and_b32 v39, 0xffff0000, v19
  v_lshlrev_b32 v40, 16, v20
  v_and_b32 v41, 0xffff0000, v20
  v_lshlrev_b32 v42, 16, v21
  v_and_b32 v43, 0xffff0000, v21
  v_lshlrev_b32 v44, 16, v22
  v_and_b32 v45, 0xffff0000, v22
  v_lshlrev_b32 v46, 16, v23
  v_and_b32 v47, 0xffff0000, v23
  v_lshlrev_b32 v48, 16, v24
  v_and_b32 v49, 0xffff0000, v24
  v_lshlrev_b32 v50, 16, v25
  v_and_b32 v51, 0xffff0000, v25
  v_lshlrev_b32 v52, 16, v26
  v_and_b32 v53, 0xffff0000, v26
  v_lshlrev_b32 v54, 16, v27
  v_and_b32 v55, 0xffff0000, v27
  v_lshlrev_b32 v56, 16, v28
  v_and_b32 v57, 0xffff0000, v28
  v_lshlrev_b32 v58, 16, v29
  v_and_b32 v59, 0xffff0000, v29
  v_lshlrev_b32 v60, 16, v30
  v_and_b32 v61, 0xffff0000, v30
  v_lshlrev_b32 v62, 16, v31
  v_and_b32 v63, 0xffff0000, v31
  v_add_f32 v64, v32, v33
  v_add_f32 v65, v34, v35
  v_add_f32 v66, v36, v37
  v_add_f32 v67, v38, v39
  v_add_f32 v64, v64, v40
  v_add_f32 v65, v65, v41
  v_add_f32 v66, v66, v42
  v_add_f32 v67, v67, v43
  v_add_f32 v64, v64, v44
  v_add_f32 v65, v65, v45
  v_add_f32 v66, v66, v46
  v_add_f32 v67, v67, v47
  v_add_f32 v64, v64, v48
  v_add_f32 v65, v65, v49
  v_add_f32 v66, v66, v50
  v_add_f32 v67, v67, v51
  v_add_f32 v64, v64, v52
  v_add_f32 v65, v65, v53
  v_add_f32 v66, v66, v54
  v_add_f32 v67, v67, v55
  v_add_f32 v64, v64, v56
  v_add_f32 v65, v65, v57
  v_add_f32 v66, v66, v58
  v_add_f32 v67, v67, v59
  v_add_f32 v64, v64, v60
  v_add_f32 v65, v65, v61
  v_add_f32 v66, v66, v62
  v_add_f32 v67, v67, v63
  v_add_f32 v64, v64, v65
  v_add_f32 v66, v66, v67
  v_add_f32 v64, v64, v66
  s_nop 1
  v_add_f32_dpp v64, v64, v64 row_ror:8 row_mask:0xf bank_mask:0xf
  s_nop 1
  v_add_f32_dpp v64, v64, v64 row_ror:4 row_mask:0xf bank_mask:0xf
  s_nop 1
  v_add_f32_dpp v64, v64, v64 row_ror:2 row_mask:0xf bank_mask:0xf
  s_nop 1
  v_add_f32_dpp v64, v64, v64 row_ror:1 row_mask:0xf bank_mask:0xf
  v_mul_f32 v64, 0x3b000000, v64
  v_mov_b32 v65, 0
  v_mov_b32 v66, 0
  v_sub_f32 v67, v32, v64
  v_sub_f32 v68, v33, v64
  v_fma_f32 v65, v67, v67, v65
  v_fma_f32 v66, v68, v68, v66
  v_sub_f32 v67, v34, v64
  v_sub_f32 v68, v35, v64
  v_fma_f32 v65, v67, v67, v65
  v_fma_f32 v66, v68, v68, v66
  v_sub_f32 v67, v36, v64
  v_sub_f32 v68, v37, v64
  v_fma_f32 v65, v67, v67, v65
  v_fma_f32 v66, v68, v68, v66
  v_sub_f32 v67, v38, v64
  v_sub_f32 v68, v39, v64
  v_fma_f32 v65, v67, v67, v65
  v_fma_f32 v66, v68, v68, v66
  v_sub_f32 v67, v40, v64
  v_sub_f32 v68, v41, v64
  v_fma_f32 v65, v67, v67, v65
  v_fma_f32 v66, v68, v68, v66
  v_sub_f32 v67, v42, v64
  v_sub_f32 v68, v43, v64
  v_fma_f32 v65, v67, v67, v65
  v_fma_f32 v66, v68, v68, v66
  v_sub_f32 v67, v44, v64
  v_sub_f32 v68, v45, v64
  v_fma_f32 v65, v67, v67, v65
  v_fma_f32 v66, v68, v68, v66
  v_sub_f32 v67, v46, v64
  v_sub_f32 v68, v47, v64
  v_fma_f32 v65, v67, v67, v65
  v_fma_f32 v66, v68, v68, v66
  v_sub_f32 v67, v48, v64
  v_sub_f32 v68, v49, v64
  v_fma_f32 v65, v67, v67, v65
  v_fma_f32 v66, v68, v68, v66
  v_sub_f32 v67, v50, v64
  v_sub_f32 v68, v51, v64
  v_fma_f32 v65, v67, v67, v65
  v_fma_f32 v66, v68, v68, v66
  v_sub_f32 v67, v52, v64
  v_sub_f32 v68, v53, v64
  v_fma_f32 v65, v67, v67, v65
  v_fma_f32 v66, v68, v68, v66
  v_sub_f32 v67, v54, v64
  v_sub_f32 v68, v55, v64
  v_fma_f32 v65, v67, v67, v65
  v_fma_f32 v66, v68, v68, v66
  v_sub_f32 v67, v56, v64
  v_sub_f32 v68, v57, v64
  v_fma_f32 v65, v67, v67, v65
  v_fma_f32 v66, v68, v68, v66
  v_sub_f32 v67, v58, v64
  v_sub_f32 v68, v59, v64
  v_fma_f32 v65, v67, v67, v65
  v_fma_f32 v66, v68, v68, v66
  v_sub_f32 v67, v60, v64
  v_sub_f32 v68, v61, v64
  v_fma_f32 v65, v67, v67, v65
  v_fma_f32 v66, v68, v68, v66
  v_sub_f32 v67, v62, v64
  v_sub_f32 v68, v63, v64
  v_fma_f32 v65, v67, v67, v65
  v_fma_f32 v66, v68, v68, v66
  v_add_f32 v65, v65, v66
  s_nop 1
  v_add_f32_dpp v65, v65, v65 row_ror:8 row_mask:0xf bank_mask:0xf
  s_nop 1
  v_add_f32_dpp v65, v65, v65 row_ror:4 row_mask:0xf bank_mask:0xf
  s_nop 1
  v_add_f32_dpp v65, v65, v65 row_ror:2 row_mask:0xf bank_mask:0xf
  s_nop 1
  v_add_f32_dpp v65, v65, v65 row_ror:1 row_mask:0xf bank_mask:0xf
  v_mul_f32 v65, 0x3b000000, v65
  v_cvt_pk_bf16_f32 v64, v64, v64
  v_and_b32 v64, 0xffff0000, v64
  v_cvt_pk_bf16_f32 v65, v65, v65
  v_and_b32 v65, 0xffff0000, v65
  v_add_f32 v65, 0x3727c5ac, v65
  v_cvt_pk_bf16_f32 v65, v65, v65
  v_and_b32 v65, 0xffff0000, v65
  v_sqrt_f32 v65, v65
  s_nop 0
  v_cvt_pk_bf16_f32 v65, v65, v65
  v_and_b32 v65, 0xffff0000, v65
  v_rcp_f32 v65, v65
  v_lshlrev_b32 v32, 16, v12
  v_and_b32 v33, 0xffff0000, v12
  v_sub_f32 v32, v32, v64
  v_sub_f32 v33, v33, v64
  v_cvt_pk_bf16_f32 v66, v32, v33
  v_lshlrev_b32 v32, 16, v66
  v_and_b32 v33, 0xffff0000, v66
  v_mul_f32 v32, v32, v65
  v_mul_f32 v33, v33, v65
  v_cvt_pk_bf16_f32 v16, v32, v33
  v_lshlrev_b32 v34, 16, v13
  v_and_b32 v35, 0xffff0000, v13
  v_sub_f32 v34, v34, v64
  v_sub_f32 v35, v35, v64
  v_cvt_pk_bf16_f32 v66, v34, v35
  v_lshlrev_b32 v34, 16, v66
  v_and_b32 v35, 0xffff0000, v66
  v_mul_f32 v34, v34, v65
  v_mul_f32 v35, v35, v65
  v_cvt_pk_bf16_f32 v17, v34, v35
  v_lshlrev_b32 v36, 16, v14
  v_and_b32 v37, 0xffff0000, v14
  v_sub_f32 v36, v36, v64
  v_sub_f32 v37, v37, v64
  v_cvt_pk_bf16_f32 v66, v36, v37
  v_lshlrev_b32 v36, 16, v66
  v_and_b32 v37, 0xffff0000, v66
  v_mul_f32 v36, v36, v65
  v_mul_f32 v37, v37, v65
  v_cvt_pk_bf16_f32 v18, v36, v37
  v_lshlrev_b32 v38, 16, v15
  v_and_b32 v39, 0xffff0000, v15
  v_sub_f32 v38, v38, v64
  v_sub_f32 v39, v39, v64
  v_cvt_pk_bf16_f32 v66, v38, v39
  v_lshlrev_b32 v38, 16, v66
  v_and_b32 v39, 0xffff0000, v66
  v_mul_f32 v38, v38, v65
  v_mul_f32 v39, v39, v65
  v_cvt_pk_bf16_f32 v19, v38, v39
  v_lshlrev_b32 v6, 8, v2
  v_lshl_add_u32 v6, v3, 4, v6
  v_add_u32 v6, 151744, v6
  ds_write_b128 v6, v[16:19]
  v_lshrrev_b32 v8, 2, v3
  v_lshl_add_u32 v8, v2, 3, v8
  v_and_b32 v9, 3, v3
  v_lshlrev_b32 v12, 3, v9
  v_lshl_add_u32 v12, v8, 7, v12
  v_add_u32 v12, 131072, v12
  v_lshlrev_b32 v13, 8, v9
  v_lshl_add_u32 v13, v2, 4, v13
  v_add_u32 v13, 151744, v13
  s_waitcnt vmcnt(0) lgkmcnt(0)
  ds_read_b128 v[16:19], v13 offset:0
  ds_read_b128 v[20:23], v13 offset:64
  ds_read_b128 v[24:27], v13 offset:128
  ds_read_b128 v[28:31], v13 offset:192
  ds_read_b64_tr_b16 v[32:33], v12 offset:0
  ds_read_b64_tr_b16 v[34:35], v12 offset:512
  ds_read_b64_tr_b16 v[36:37], v12 offset:32
  ds_read_b64_tr_b16 v[38:39], v12 offset:544
  ds_read_b64_tr_b16 v[40:41], v12 offset:64
  ds_read_b64_tr_b16 v[42:43], v12 offset:576
  ds_read_b64_tr_b16 v[44:45], v12 offset:96
  ds_read_b64_tr_b16 v[46:47], v12 offset:608
  s_waitcnt lgkmcnt(6)
  v_mfma_f32_16x16x32_bf16 v[64:67], v[32:35], v[16:19], 0
  s_waitcnt lgkmcnt(4)
  v_mfma_f32_16x16x32_bf16 v[68:71], v[36:39], v[16:19], 0
  s_waitcnt lgkmcnt(2)
  v_mfma_f32_16x16x32_bf16 v[72:75], v[40:43], v[16:19], 0
  s_waitcnt lgkmcnt(0)
  v_mfma_f32_16x16x32_bf16 v[76:79], v[44:47], v[16:19], 0
  ds_read_b64_tr_b16 v[32:33], v12 offset:4096
  ds_read_b64_tr_b16 v[34:35], v12 offset:4608
  ds_read_b64_tr_b16 v[36:37], v12 offset:4128
  ds_read_b64_tr_b16 v[38:39], v12 offset:4640
  ds_read_b64_tr_b16 v[40:41], v12 offset:4160
  ds_read_b64_tr_b16 v[42:43], v12 offset:4672
  ds_read_b64_tr_b16 v[44:45], v12 offset:4192
  ds_read_b64_tr_b16 v[46:47], v12 offset:4704
  s_waitcnt lgkmcnt(6)
  v_mfma_f32_16x16x32_bf16 v[64:67], v[32:35], v[20:23], v[64:67]
  s_waitcnt lgkmcnt(4)
  v_mfma_f32_16x16x32_bf16 v[68:71], v[36:39], v[20:23], v[68:71]
  s_waitcnt lgkmcnt(2)
  v_mfma_f32_16x16x32_bf16 v[72:75], v[40:43], v[20:23], v[72:75]
  s_waitcnt lgkmcnt(0)
  v_mfma_f32_16x16x32_bf16 v[76:79], v[44:47], v[20:23], v[76:79]
  ds_read_b64_tr_b16 v[32:33], v12 offset:8192
  ds_read_b64_tr_b16 v[34:35], v12 offset:8704
  ds_read_b64_tr_b16 v[36:37], v12 offset:8224
  ds_read_b64_tr_b16 v[38:39], v12 offset:8736
  ds_read_b64_tr_b16 v[40:41], v12 offset:8256
  ds_read_b64_tr_b16 v[42:43], v12 offset:8768
  ds_read_b64_tr_b16 v[44:45], v12 offset:8288
  ds_read_b64_tr_b16 v[46:47], v12 offset:8800
  s_waitcnt lgkmcnt(6)
  v_mfma_f32_16x16x32_bf16 v[64:67], v[32:35], v[24:27], v[64:67]
  s_waitcnt lgkmcnt(4)
  v_mfma_f32_16x16x32_bf16 v[68:71], v[36:39], v[24:27], v[68:71]
  s_waitcnt lgkmcnt(2)
  v_mfma_f32_16x16x32_bf16 v[72:75], v[40:43], v[24:27], v[72:75]
  s_waitcnt lgkmcnt(0)
  v_mfma_f32_16x16x32_bf16 v[76:79], v[44:47], v[24:27], v[76:79]
  ds_read_b64_tr_b16 v[32:33], v12 offset:12288
  ds_read_b64_tr_b16 v[34:35], v12 offset:12800
  ds_read_b64_tr_b16 v[36:37], v12 offset:12320
  ds_read_b64_tr_b16 v[38:39], v12 offset:12832
  ds_read_b64_tr_b16 v[40:41], v12 offset:12352
  ds_read_b64_tr_b16 v[42:43], v12 offset:12864
  ds_read_b64_tr_b16 v[44:45], v12 offset:12384
  ds_read_b64_tr_b16 v[46:47], v12 offset:12896
  s_waitcnt lgkmcnt(6)
  v_mfma_f32_16x16x32_bf16 v[64:67], v[32:35], v[28:31], v[64:67]
  s_waitcnt lgkmcnt(4)
  v_mfma_f32_16x16x32_bf16 v[68:71], v[36:39], v[28:31], v[68:71]
  s_waitcnt lgkmcnt(2)
  v_mfma_f32_16x16x32_bf16 v[72:75], v[40:43], v[28:31], v[72:75]
  s_waitcnt lgkmcnt(0)
  v_mfma_f32_16x16x32_bf16 v[76:79], v[44:47], v[28:31], v[76:79]
  v_mov_b32 v34, s42
  v_mov_b32 v35, s43
  v_mov_b32 v38, s42
  v_mov_b32 v39, s43
  s_mov_b32 exec_lo, 0x000f000f
  s_mov_b32 exec_hi, 0x000f000f
  s_nop 4
  v_mov_b32 v32, v64
  v_mov_b32 v33, v65
  v_mov_b32 v36, v66
  v_mov_b32 v37, v67
  global_store_dwordx4 v103, v[32:35], s[32:33] offset:0 sc1
  global_store_dwordx4 v103, v[36:39], s[32:33] offset:16 sc1
  s_nop 1
  v_mov_b32 v32, v68
  v_mov_b32 v33, v69
  v_mov_b32 v36, v70
  v_mov_b32 v37, v71
  global_store_dwordx4 v103, v[32:35], s[32:33] offset:128 sc1
  global_store_dwordx4 v103, v[36:39], s[32:33] offset:144 sc1
  s_nop 1
  v_mov_b32 v32, v72
  v_mov_b32 v33, v73
  v_mov_b32 v36, v74
  v_mov_b32 v37, v75
  global_store_dwordx4 v103, v[32:35], s[32:33] offset:256 sc1
  global_store_dwordx4 v103, v[36:39], s[32:33] offset:272 sc1
  s_nop 1
  v_mov_b32 v32, v76
  v_mov_b32 v33, v77
  v_mov_b32 v36, v78
  v_mov_b32 v37, v79
  global_store_dwordx4 v103, v[32:35], s[32:33] offset:384 sc1
  global_store_dwordx4 v103, v[36:39], s[32:33] offset:400 sc1
  s_nop 1
  s_mov_b64 exec, -1
  s_mov_b64 exec, 1
  ds_write_b32 v100, v101 offset:12
  s_mov_b64 exec, -1
  s_branch L_c_pre
L_c1:
  s_lshl_b32 s44, s34, 16
  s_lshl_b32 s45, s36, 14
  s_add_u32 s44, s44, s45
  s_add_u32 s44, s44, 65536
  v_lshlrev_b32 v6, 4, v0
  v_add_u32 v6, s44, v6
  v_add_u32 v7, 4096, v6
  v_add_u32 v8, 4096, v7
  v_add_u32 v9, 4096, v8
  s_waitcnt lgkmcnt(0)
  s_not_b32 s43, s62
  s_add_u32 s42, s62, 1
  s_mov_b32 s61, 100000
L_poll_15:
  ds_read_b32 v20, v100 offset:4
  s_waitcnt lgkmcnt(0)
  v_cmp_gt_u32 vcc, 6, v20
  s_cbranch_vccz L_pdone_16
  s_sub_u32 s61, s61, 1
  s_cbranch_scc1 L_pdone_16
  s_sleep 4
  s_branch L_poll_15
L_pdone_16:
  s_mov_b32 s60, 100000
L_poll_17:
  global_load_dwordx4 v[32:35], v6, s[32:33] offset:0 sc1
  global_load_dwordx4 v[36:39], v6, s[32:33] offset:1024 sc1
  global_load_dwordx4 v[40:43], v6, s[32:33] offset:2048 sc1
  global_load_dwordx4 v[44:47], v6, s[32:33] offset:3072 sc1
  global_load_dwordx4 v[48:51], v7, s[32:33] offset:0 sc1
  global_load_dwordx4 v[52:55], v7, s[32:33] offset:1024 sc1
  global_load_dwordx4 v[56:59], v7, s[32:33] offset:2048 sc1
  global_load_dwordx4 v[60:63], v7, s[32:33] offset:3072 sc1
  global_load_dwordx4 v[64:67], v8, s[32:33] offset:0 sc1
  global_load_dwordx4 v[68:71], v8, s[32:33] offset:1024 sc1
  global_load_dwordx4 v[72:75], v8, s[32:33] offset:2048 sc1
  global_load_dwordx4 v[76:79], v8, s[32:33] offset:3072 sc1
  global_load_dwordx4 v[80:83], v9, s[32:33] offset:0 sc1
  global_load_dwordx4 v[84:87], v9, s[32:33] offset:1024 sc1
  global_load_dwordx4 v[88:91], v9, s[32:33] offset:2048 sc1
  global_load_dwordx4 v[92:95], v9, s[32:33] offset:3072 sc1
  s_mov_b64 exec, 1
  ds_write_b32 v100, v101 offset:16
  s_mov_b64 exec, -1
  s_waitcnt vmcnt(0)
  v_xor_b32 v34, s42, v34
  v_xor_b32 v35, s43, v35
  v_xor_b32 v38, s42, v38
  v_xor_b32 v39, s43, v39
  v_xor_b32 v42, s42, v42
  v_xor_b32 v43, s43, v43
  v_xor_b32 v46, s42, v46
  v_xor_b32 v47, s43, v47
  v_xor_b32 v50, s42, v50
  v_xor_b32 v51, s43, v51
  v_xor_b32 v54, s42, v54
  v_xor_b32 v55, s43, v55
  v_xor_b32 v58, s42, v58
  v_xor_b32 v59, s43, v59
  v_xor_b32 v62, s42, v62
  v_xor_b32 v63, s43, v63
  v_xor_b32 v66, s42, v66
  v_xor_b32 v67, s43, v67
  v_xor_b32 v70, s42, v70
  v_xor_b32 v71, s43, v71
  v_xor_b32 v74, s42, v74
  v_xor_b32 v75, s43, v75
  v_xor_b32 v78, s42, v78
  v_xor_b32 v79, s43, v79
  v_xor_b32 v82, s42, v82
  v_xor_b32 v83, s43, v83
  v_xor_b32 v86, s42, v86
  v_xor_b32 v87, s43, v87
  v_xor_b32 v90, s42, v90
  v_xor_b32 v91, s43, v91
  v_xor_b32 v94, s42, v94
  v_xor_b32 v95, s43, v95
  v_or3_b32 v20, v34, v35, v38
  v_or_b32 v20, v20, v39
  v_or3_b32 v20, v20, v42, v43
  v_or3_b32 v20, v20, v46, v47
  v_or3_b32 v20, v20, v50, v51
  v_or3_b32 v20, v20, v54, v55
  v_or3_b32 v20, v20, v58, v59
  v_or3_b32 v20, v20, v62, v63
  v_or3_b32 v20, v20, v66, v67
  v_or3_b32 v20, v20, v70, v71
  v_or3_b32 v20, v20, v74, v75
  v_or3_b32 v20, v20, v78, v79
  v_or3_b32 v20, v20, v82, v83
  v_or3_b32 v20, v20, v86, v87
  v_or3_b32 v20, v20, v90, v91
  v_or3_b32 v20, v20, v94, v95
  v_cmp_ne_u32 vcc, 0, v20
  s_cbranch_vccz L_pdone_18
  s_sub_u32 s60, s60, 1
  s_cbranch_scc1 L_pdone_18
  s_sleep 8
  s_branch L_poll_17
L_pdone_18:
  v_pk_add_f32 v[32:33], v[32:33], v[48:49]
  v_pk_add_f32 v[64:65], v[64:65], v[80:81]
  v_pk_add_f32 v[32:33], v[32:33], v[64:65]
  v_pk_add_f32 v[36:37], v[36:37], v[52:53]
  v_pk_add_f32 v[68:69], v[68:69], v[84:85]
  v_pk_add_f32 v[36:37], v[36:37], v[68:69]
  v_pk_add_f32 v[40:41], v[40:41], v[56:57]
  v_pk_add_f32 v[72:73], v[72:73], v[88:89]
  v_pk_add_f32 v[40:41], v[40:41], v[72:73]
  v_pk_add_f32 v[44:45], v[44:45], v[60:61]
  v_pk_add_f32 v[76:77], v[76:77], v[92:93]
  v_pk_add_f32 v[44:45], v[44:45], v[76:77]
  v_cvt_pk_bf16_f32 v16, v32, v33
  v_cvt_pk_bf16_f32 v17, v36, v37
  v_cvt_pk_bf16_f32 v18, v40, v41
  v_cvt_pk_bf16_f32 v19, v44, v45
  v_lshlrev_b32 v7, 2, v0
  v_add_u32 v7, 155840, v7
  ds_write_b32 v7, v16 offset:0
  ds_write_b32 v7, v17 offset:256
  ds_write_b32 v7, v18 offset:512
  ds_write_b32 v7, v19 offset:768
  s_mov_b64 exec, 1
  ds_write_b32 v100, v101 offset:0
  s_mov_b64 exec, -1
  s_branch L_c_pre
L_c2:
  v_mov_b32 v12, -1
  v_mov_b32 v13, -1
  v_mov_b32 v14, -1
  v_mov_b32 v15, -1
  v_lshrrev_b32 v16, 5, v0
  v_lshlrev_b32 v16, 14, v16
  v_and_b32 v17, 31, v0
  v_lshl_add_u32 v16, v17, 4, v16
  s_lshl_b32 s44, s34, 16
  s_lshl_b32 s45, s36, 12
  s_add_u32 s44, s44, s45
  s_lshl_b32 s45, s37, 9
  s_add_u32 s44, s44, s45
  s_add_u32 s44, s44, 589824
  v_add_u32 v16, s44, v16
  global_store_dwordx4 v16, v[12:15], s[32:33] sc1
  v_add_u32 v17, 0x8000, v16
  global_store_dwordx4 v17, v[12:15], s[32:33] sc1
  global_store_dwordx2 v102, v[12:13], s[32:33] sc1
  v_lshlrev_b32 v18, 4, v2
  v_bfe_u32 v19, v0, 3, 1
  v_add_u32 v18, v18, v19
  v_lshlrev_b32 v18, 12, v18
  v_and_b32 v19, 7, v0
  v_lshl_add_u32 v18, v19, 4, v18
  s_lshl_b32 s45, s38, 7
  s_add_u32 s45, s45, 1114112
  s_cmp_lg_u32 s40, 0
  s_cbranch_scc1 L_c2h
  s_lshl_b32 s44, s37, 13
  s_add_u32 s44, s44, s45
  v_add_u32 v19, s44, v18
  global_store_dwordx4 v19, v[12:15], s[32:33] sc1
  s_cmp_eq_u32 s63, 0
  s_cbranch_scc1 L_c2h
  s_sub_u32 s44, s37, 2
  s_and_b32 s44, s44, 7
  s_lshl_b32 s44, s44, 13
  s_add_u32 s44, s44, s45
  v_add_u32 v19, s44, v18
  global_store_dwordx4 v19, v[12:15], s[32:33] sc1
L_c2h:
  s_cmp_eq_u32 s39, 0
  s_cbranch_scc1 L_c2a
  s_lshl_b32 s44, s36, 11
  s_lshl_b32 s45, s6, 7
  s_add_u32 s44, s44, s45
  s_add_u32 s44, s44, 1835008
  v_lshrrev_b32 v19, 3, v0
  v_lshlrev_b32 v19, 13, v19
  v_and_b32 v20, 7, v0
  v_lshl_add_u32 v19, v20, 4, v19
  v_add_u32 v19, s44, v19
  global_store_dwordx4 v19, v[12:15], s[32:33] sc1
L_c2a:
  s_cmp_eq_u32 s40, 0
  s_cbranch_scc1 L_c2b
  v_lshrrev_b32 v19, 3, v0
  v_mul_u32_u24 v19, 7168, v19
  v_and_b32 v20, 7, v0
  v_lshl_add_u32 v19, v20, 4, v19
  s_lshl_b32 s44, s41, 7
  s_add_u32 s44, s44, 1376256
  v_add_u32 v19, s44, v19
  global_store_dwordx4 v19, v[12:15], s[32:33] sc1
  v_add_u32 v19, 57344, v19
  global_store_dwordx4 v19, v[12:15], s[32:33] sc1
  v_add_u32 v19, 57344, v19
  global_store_dwordx4 v19, v[12:15], s[32:33] sc1
  v_add_u32 v19, 57344, v19
  global_store_dwordx4 v19, v[12:15], s[32:33] sc1
  v_add_u32 v19, 57344, v19
  global_store_dwordx4 v19, v[12:15], s[32:33] sc1
  v_add_u32 v19, 57344, v19
  global_store_dwordx4 v19, v[12:15], s[32:33] sc1
  v_add_u32 v19, 57344, v19
  global_store_dwordx4 v19, v[12:15], s[32:33] sc1
  v_add_u32 v19, 57344, v19
  global_store_dwordx4 v19, v[12:15], s[32:33] sc1
  v_add_u32 v19, 57344, v19
L_c2b:
  s_waitcnt vmcnt(0)
  s_waitcnt lgkmcnt(0)
  s_not_b32 s43, s62
  s_add_u32 s42, s62, 1
  s_getreg_b32 s44, hwreg(HW_REG_XCC_ID)
  s_and_b32 s44, s44, 7
  s_xor_b32 s44, s44, s43
  v_mov_b32 v20, s42
  v_mov_b32 v21, s44
  s_lshl_b32 s44, s34, 5
  s_add_u32 s44, s44, s35
  s_lshl_b32 s44, s44, 3
  s_add_u32 s44, s44, 4096
  v_mov_b32 v22, s44
  s_mov_b64 exec, 1
  global_store_dwordx2 v22, v[20:21], s[32:33] sc1
  s_mov_b64 exec, -1
  s_branch L_c_join
L_c3:
  s_lshl_b32 s45, s36, 3
  s_add_u32 s45, s45, s34
  s_lshl_b32 s45, s45, 20
  s_lshl_b32 s46, s37, 17
  s_add_u32 s45, s45, s46
  s_add_u32 s46, s12, s45
  s_addc_u32 s47, s13, 0
  s_load_dword s7, s[46:47], 0
  s_lshl_b32 s45, s38, 17
  s_add_u32 s48, s16, s45
  s_addc_u32 s49, s17, 0
  s_load_dword s7, s[48:49], 0
  s_cmp_eq_u32 s40, 0
  s_cbranch_scc1 L_c3_nt
  s_load_dword s7, s[20:21], 0
  s_load_dword s7, s[20:21], 0xf0000
  s_load_dword s7, s[24:25], 0
  s_load_dword s7, s[24:25], 0xf0000
  s_add_u32 s46, s20, 0x1b0000
  s_addc_u32 s47, s21, 0
  s_load_dword s7, s[46:47], 0
  s_add_u32 s48, s24, 0x1b0000
  s_addc_u32 s49, s25, 0
  s_load_dword s7, s[48:49], 0
L_c3_nt:
  s_cmp_ge_u32 s35, 2
  s_cbranch_scc1 L_c3_nopf
  s_getpc_b64 s[44:45]
L_pc_here:
  s_sub_u32 s44, s44, L_pc_here-sequential_preLN__gqa_block_cached__mixer_channel_mlp__decode_kernel
  s_subb_u32 s45, s45, 0
  v_lshlrev_b32 v6, 4, v0
  global_load_dwordx4 v[32:35], v6, s[44:45]
  v_add_u32 v6, 1024, v6
  global_load_dwordx4 v[32:35], v6, s[44:45]
  v_add_u32 v6, 1024, v6
  global_load_dwordx4 v[32:35], v6, s[44:45]
  v_add_u32 v6, 1024, v6
  global_load_dwordx4 v[32:35], v6, s[44:45]
  v_add_u32 v6, 1024, v6
  global_load_dwordx4 v[32:35], v6, s[44:45]
  v_add_u32 v6, 1024, v6
  global_load_dwordx4 v[32:35], v6, s[44:45]
  v_add_u32 v6, 1024, v6
  global_load_dwordx4 v[32:35], v6, s[44:45]
  v_add_u32 v6, 1024, v6
  global_load_dwordx4 v[32:35], v6, s[44:45]
  v_add_u32 v6, 1024, v6
  global_load_dwordx4 v[32:35], v6, s[44:45]
  v_add_u32 v6, 1024, v6
  global_load_dwordx4 v[32:35], v6, s[44:45]
  v_add_u32 v6, 1024, v6
  global_load_dwordx4 v[32:35], v6, s[44:45]
  v_add_u32 v6, 1024, v6
  global_load_dwordx4 v[32:35], v6, s[44:45]
  v_add_u32 v6, 1024, v6
  global_load_dwordx4 v[32:35], v6, s[44:45]
  v_add_u32 v6, 1024, v6
  global_load_dwordx4 v[32:35], v6, s[44:45]
  v_add_u32 v6, 1024, v6
L_c3_nopf:
  s_cmp_eq_u32 s40, 0
  s_cbranch_scc1 L_c3a
  s_lshl_b32 s44, s41, 6
  v_and_b32 v6, 31, v0
  v_lshlrev_b32 v7, 1, v6
  v_add_u32 v7, s44, v7
  global_load_ushort v8, v7, s[22:23]
  v_lshlrev_b32 v6, 2, v6
  v_add_u32 v6, 158272, v6
  s_waitcnt vmcnt(0)
  v_lshlrev_b32 v8, 16, v8
  ds_write_b32 v6, v8
L_c3a:
  s_waitcnt lgkmcnt(0)
  s_not_b32 s43, s62
  s_add_u32 s42, s62, 1
  s_mov_b32 s61, 100000
L_poll_19:
  ds_read_b32 v20, v100 offset:16
  s_waitcnt lgkmcnt(0)
  v_cmp_ne_u32 vcc, 1, v20
  s_cbranch_vccz L_pdone_20
  s_sub_u32 s61, s61, 1
  s_cbranch_scc1 L_pdone_20
  s_sleep 4
  s_branch L_poll_19
L_pdone_20:
  v_lshlrev_b32 v8, 4, v0
  v_add_u32 v8, 4096, v8
  s_mov_b32 s60, 100000
L_poll_21:
  global_load_dwordx4 v[16:19], v8, s[32:33] sc1
  global_load_dwordx4 v[20:23], v8, s[32:33] offset:1024 sc1
  s_waitcnt vmcnt(0)
  v_xor_b32 v16, s42, v16
  v_xor_b32 v17, s43, v17
  v_xor_b32 v18, s42, v18
  v_xor_b32 v19, s43, v19
  v_xor_b32 v20, s42, v20
  v_xor_b32 v21, s43, v21
  v_xor_b32 v22, s42, v22
  v_xor_b32 v23, s43, v23
  v_or3_b32 v24, v16, v18, v20
  v_or_b32 v24, v24, v22
  v_or3_b32 v25, v17, v19, v21
  v_or_b32 v25, v25, v23
  v_lshrrev_b32 v25, 3, v25
  v_or_b32 v24, v24, v25
  v_cmp_ne_u32 vcc, 0, v24
  s_cbranch_vccz L_pdone_22
  s_sub_u32 s60, s60, 1
  s_cbranch_scc1 L_pdone_22
  s_sleep 8
  s_branch L_poll_21
L_pdone_22:
  s_getreg_b32 s44, hwreg(HW_REG_XCC_ID)
  s_and_b32 s44, s44, 7
  s_cmp_lt_u32 s34, 4
  s_cbranch_scc1 L_c3lo
  v_mov_b32 v17, v21
  v_mov_b32 v19, v23
L_c3lo:
  v_xor_b32 v17, s44, v17
  v_xor_b32 v19, s44, v19
  v_or_b32 v17, v17, v19
  v_xor_b32 v24, s34, v2
  v_and_b32 v24, 3, v24
  v_cmp_eq_u32 vcc, 0, v24
  s_nop 1
  v_cndmask_b32 v17, 0, v17, vcc
  v_cmp_ne_u32 vcc, 0, v17
  s_cmp_eq_u64 vcc, 0
  s_cbranch_scc0 L_c3nf
  s_mov_b64 exec, 1
  ds_write_b32 v100, v101 offset:32
  s_mov_b64 exec, -1
L_c3nf:
  s_mov_b64 exec, 1
  ds_write_b32 v100, v101 offset:40
  s_mov_b64 exec, -1
  s_branch L_c_join
L_c_pre:
L_c_join:
  v_and_b32 v9, 7, v0
  v_lshlrev_b32 v9, 3, v9
  s_lshl_b32 s44, s36, 10
  s_lshl_b32 s45, s6, 6
  s_add_u32 s44, s44, s45
  v_add_u32 v126, s44, v9
  v_add_u32 v11, s45, v9
  global_load_dwordx2 v[120:121], v126, s[8:9]
  global_load_dwordx2 v[122:123], v11, s[26:27]
  global_load_dwordx2 v[124:125], v126, s[28:29]
  s_lshl_b32 s44, s38, 14
  s_lshl_b32 s45, s3, 12
  s_add_u32 s44, s44, s45
  s_add_u32 s44, s44, 589824
  v_lshlrev_b32 v6, 4, v0
  v_add_u32 v6, s44, v6
  s_lshl_b32 s44, s38, 8
  s_lshl_b32 s45, s3, 6
  s_add_u32 s44, s44, s45
  s_add_u32 s44, s44, 8192
  v_lshrrev_b32 v7, 5, v0
  v_lshlrev_b32 v7, 5, v7
  v_add_u32 v7, s44, v7
  v_and_b32 v8, 31, v0
  v_lshlrev_b32 v8, 3, v8
  s_lshl_b32 s45, s3, 8
  s_add_u32 s45, s45, 156992
  v_add_u32 v8, s45, v8
  v_lshrrev_b32 v9, 2, v3
  v_lshlrev_b32 v9, 8, v9
  v_lshl_add_u32 v9, v2, 4, v9
  v_add_u32 v9, 156992, v9
  v_lshlrev_b32 v10, 16, v2
  v_lshl_add_u32 v10, v3, 2, v10
  s_lshl_b32 s45, s38, 7
  s_lshr_b32 s46, s3, 1
  s_lshl_b32 s46, s46, 12
  s_add_u32 s45, s45, s46
  s_and_b32 s46, s3, 1
  s_lshl_b32 s46, s46, 6
  s_add_u32 s45, s45, s46
  s_add_u32 s45, s45, 1114112
  s_sub_u32 s55, s37, 2
  s_and_b32 s55, s55, 7
  s_lshl_b32 s44, s55, 13
  s_add_u32 s44, s44, s45
  v_add_u32 v99, s44, v10
  s_lshl_b32 s44, s37, 13
  s_add_u32 s44, s44, s45
  v_add_u32 v10, s44, v10
  v_lshrrev_b32 v11, 2, v3
  v_lshlrev_b32 v11, 14, v11
  v_lshl_add_u32 v11, v2, 7, v11
  v_and_b32 v13, 3, v3
  v_lshl_add_u32 v11, v13, 4, v11
  s_lshl_b32 s44, s34, 16
  s_lshl_b32 s45, s36, 12
  s_add_u32 s44, s44, s45
  s_lshl_b32 s45, s37, 9
  s_add_u32 s44, s44, s45
  s_lshl_b32 s45, s3, 6
  s_add_u32 s44, s44, s45
  s_add_u32 s44, s44, 589824
  v_add_u32 v11, s44, v11
  v_lshlrev_b32 v13, 4, v0
  s_lshl_b32 s45, s3, 10
  s_add_u32 s45, s45, 8192
  v_add_u32 v13, s45, v13
  v_lshrrev_b32 v14, 2, v3
  v_lshl_add_u32 v14, v2, 3, v14
  v_and_b32 v15, 3, v3
  v_lshlrev_b32 v12, 3, v15
  v_lshl_add_u32 v12, v14, 7, v12
  s_lshl_b32 s44, s3, 5
  v_add_u32 v98, s44, v12
  v_add_u32 v12, 131072, v98
  s_mov_b32 s54, 0x3fb8aa3b
  v_bfe_u32 v16, v0, 3, 2
  v_lshlrev_b32 v16, 3, v16
  v_lshrrev_b32 v17, 5, v0
  v_add_u32 v16, v16, v17
  v_lshlrev_b32 v16, 10, v16
  v_and_b32 v17, 7, v0
  v_lshl_add_u32 v97, v17, 4, v16
  s_sub_u32 s55, s37, 2
  s_and_b32 s55, s55, 7
  s_lshl_b32 s44, s38, 17
  s_lshl_b32 s45, s3, 15
  s_add_u32 s44, s44, s45
  s_lshl_b32 s45, s37, 7
  s_add_u32 s45, s45, s44
  s_add_u32 s46, s16, s45
  s_addc_u32 s47, s17, 0
  s_lshl_b32 s45, s55, 7
  s_add_u32 s45, s45, s44
  s_add_u32 s50, s16, s45
  s_addc_u32 s51, s17, 0
  s_lshl_b32 s48, s3, 12
  s_add_u32 s48, s48, 131072
  s_cmp_lg_u32 s40, 0
  s_cbranch_scc1 L_c_nowo
  s_mov_b32 s61, 100000
L_poll_23:
  ds_read_b32 v20, v100 offset:8
  ds_read_b32 v21, v100 offset:12
  s_waitcnt lgkmcnt(0)
  v_xor_b32 v20, 8, v20
  v_xor_b32 v21, 1, v21
  v_or_b32 v20, v20, v21
  v_cmp_ne_u32 vcc, 0, v20
  s_cbranch_vccz L_pdone_24
  s_sub_u32 s61, s61, 1
  s_cbranch_scc1 L_pdone_24
  s_sleep 2
  s_branch L_poll_23
L_pdone_24:
  s_mov_b32 m0, s48
  s_add_u32 s48, s48, 1024
  global_load_lds_dwordx4 v97, s[46:47] nt
  s_add_u32 s46, s46, 2048
  s_addc_u32 s47, s47, 0
  s_mov_b32 m0, s48
  s_add_u32 s48, s48, 1024
  global_load_lds_dwordx4 v97, s[46:47] nt
  s_add_u32 s46, s46, 2048
  s_addc_u32 s47, s47, 0
  s_mov_b32 m0, s48
  s_add_u32 s48, s48, 1024
  global_load_lds_dwordx4 v97, s[46:47] nt
  s_add_u32 s46, s46, 2048
  s_addc_u32 s47, s47, 0
  s_mov_b32 m0, s48
  s_add_u32 s48, s48, 1024
  global_load_lds_dwordx4 v97, s[46:47] nt
  s_add_u32 s46, s46, 2048
  s_addc_u32 s47, s47, 0
L_c_nowo:
  s_cmp_eq_u32 s63, 0
  s_cbranch_scc1 L_c_nowo2
  s_mov_b32 s61, 100000
L_poll_25:
  ds_read_b32 v20, v100 offset:36
  s_waitcnt lgkmcnt(0)
  v_cmp_ne_u32 vcc, 8, v20
  s_cbranch_vccz L_pdone_26
  s_sub_u32 s61, s61, 1
  s_cbranch_scc1 L_pdone_26
  s_sleep 2
  s_branch L_poll_25
L_pdone_26:
  s_lshr_b32 s48, s3, 1
  s_lshl_b32 s48, s48, 14
  s_and_b32 s45, s3, 1
  s_lshl_b32 s45, s45, 12
  s_add_u32 s48, s48, s45
  s_mov_b32 m0, s48
  s_add_u32 s48, s48, 1024
  global_load_lds_dwordx4 v97, s[50:51] nt
  s_add_u32 s50, s50, 2048
  s_addc_u32 s51, s51, 0
  s_mov_b32 m0, s48
  s_add_u32 s48, s48, 1024
  global_load_lds_dwordx4 v97, s[50:51] nt
  s_add_u32 s50, s50, 2048
  s_addc_u32 s51, s51, 0
  s_mov_b32 m0, s48
  s_add_u32 s48, s48, 1024
  global_load_lds_dwordx4 v97, s[50:51] nt
  s_add_u32 s50, s50, 2048
  s_addc_u32 s51, s51, 0
  s_mov_b32 m0, s48
  s_add_u32 s48, s48, 1024
  global_load_lds_dwordx4 v97, s[50:51] nt
  s_add_u32 s50, s50, 2048
  s_addc_u32 s51, s51, 0
L_c_nowo2:
  s_cmp_eq_u32 s40, 0
  s_cbranch_scc1 L_c_nodw
  s_cmp_lg_u32 s3, 3
  s_cbranch_scc1 L_c_nodw
  s_mov_b32 s61, 100000
L_poll_27:
  ds_read_b32 v20, v100 offset:24
  s_waitcnt lgkmcnt(0)
  v_cmp_ne_u32 vcc, 8, v20
  s_cbranch_vccz L_pdone_28
  s_sub_u32 s61, s61, 1
  s_cbranch_scc1 L_pdone_28
  s_sleep 2
  s_branch L_poll_27
L_pdone_28:
  s_mov_b32 s61, 100000
L_poll_29:
  ds_read_b32 v20, v100 offset:36
  ds_read_b32 v21, v100 offset:8
  s_waitcnt lgkmcnt(0)
  v_xor_b32 v20, 8, v20
  v_xor_b32 v21, 8, v21
  v_or_b32 v20, v20, v21
  v_cmp_ne_u32 vcc, 0, v20
  s_cbranch_vccz L_pdone_30
  s_sub_u32 s61, s61, 1
  s_cbranch_scc1 L_pdone_30
  s_sleep 2
  s_branch L_poll_29
L_pdone_30:
L_c_dw:
  s_mul_i32 s44, s3, 458752
  s_lshl_b32 s45, s41, 6
  s_add_u32 s44, s44, s45
  s_add_u32 s46, s20, s44
  s_addc_u32 s47, s21, 0
  s_lshl_b32 s44, s41, 15
  s_lshl_b32 s45, s3, 8
  s_add_u32 s44, s44, s45
  s_add_u32 s50, s24, s44
  s_addc_u32 s51, s25, 0
  v_lshrrev_b32 v4, 2, v0
  v_mul_u32_u24 v4, 3584, v4
  v_and_b32 v5, 3, v0
  v_lshl_add_u32 v4, v5, 4, v4
  v_lshrrev_b32 v5, 3, v0
  v_lshlrev_b32 v5, 10, v5
  v_and_b32 v6, 7, v0
  v_lshl_add_u32 v5, v6, 4, v5
  s_lshl_b32 s48, s3, 15
  s_mov_b32 m0, s48
  s_add_u32 s48, s48, 1024
  global_load_lds_dwordx4 v4, s[46:47]
  s_add_u32 s46, s46, 57344
  s_addc_u32 s47, s47, 0
  s_mov_b32 m0, s48
  s_add_u32 s48, s48, 1024
  global_load_lds_dwordx4 v4, s[46:47]
  s_add_u32 s46, s46, 57344
  s_addc_u32 s47, s47, 0
  s_mov_b32 m0, s48
  s_add_u32 s48, s48, 1024
  global_load_lds_dwordx4 v4, s[46:47]
  s_add_u32 s46, s46, 57344
  s_addc_u32 s47, s47, 0
  s_mov_b32 m0, s48
  s_add_u32 s48, s48, 1024
  global_load_lds_dwordx4 v4, s[46:47]
  s_add_u32 s46, s46, 57344
  s_addc_u32 s47, s47, 0
  s_mov_b32 m0, s48
  s_add_u32 s48, s48, 1024
  global_load_lds_dwordx4 v5, s[50:51] nt
  s_add_u32 s50, s50, 8192
  s_addc_u32 s51, s51, 0
  s_mov_b32 m0, s48
  s_add_u32 s48, s48, 1024
  global_load_lds_dwordx4 v5, s[50:51] nt
  s_add_u32 s50, s50, 8192
  s_addc_u32 s51, s51, 0
  s_mov_b32 m0, s48
  s_add_u32 s48, s48, 1024
  global_load_lds_dwordx4 v5, s[50:51] nt
  s_add_u32 s50, s50, 8192
  s_addc_u32 s51, s51, 0
  s_mov_b32 m0, s48
  s_add_u32 s48, s48, 1024
  global_load_lds_dwordx4 v5, s[50:51] nt
  s_add_u32 s50, s50, 8192
  s_addc_u32 s51, s51, 0
  s_add_u32 s48, s48, 8192
  s_sub_u32 s50, s50, 32640
  s_subb_u32 s51, s51, 0
  s_mov_b32 m0, s48
  s_add_u32 s48, s48, 1024
  global_load_lds_dwordx4 v4, s[46:47]
  s_add_u32 s46, s46, 57344
  s_addc_u32 s47, s47, 0
  s_mov_b32 m0, s48
  s_add_u32 s48, s48, 1024
  global_load_lds_dwordx4 v4, s[46:47]
  s_add_u32 s46, s46, 57344
  s_addc_u32 s47, s47, 0
  s_mov_b32 m0, s48
  s_add_u32 s48, s48, 1024
  global_load_lds_dwordx4 v4, s[46:47]
  s_add_u32 s46, s46, 57344
  s_addc_u32 s47, s47, 0
  s_mov_b32 m0, s48
  s_add_u32 s48, s48, 1024
  global_load_lds_dwordx4 v4, s[46:47]
  s_add_u32 s46, s46, 57344
  s_addc_u32 s47, s47, 0
  s_mov_b32 m0, s48
  s_add_u32 s48, s48, 1024
  global_load_lds_dwordx4 v5, s[50:51] nt
  s_add_u32 s50, s50, 8192
  s_addc_u32 s51, s51, 0
  s_mov_b32 m0, s48
  s_add_u32 s48, s48, 1024
  global_load_lds_dwordx4 v5, s[50:51] nt
  s_add_u32 s50, s50, 8192
  s_addc_u32 s51, s51, 0
  s_mov_b32 m0, s48
  s_add_u32 s48, s48, 1024
  global_load_lds_dwordx4 v5, s[50:51] nt
  s_add_u32 s50, s50, 8192
  s_addc_u32 s51, s51, 0
  s_mov_b32 m0, s48
  s_add_u32 s48, s48, 1024
  global_load_lds_dwordx4 v5, s[50:51] nt
  s_add_u32 s50, s50, 8192
  s_addc_u32 s51, s51, 0
  s_waitcnt vmcnt(0)
  s_mov_b64 exec, 1
  ds_add_u32 v100, v101 offset:28
  s_mov_b64 exec, -1
  s_branch L_chain_end
L_c_nodw:
  v_and_b32 v14, 3, v0
  v_lshlrev_b32 v15, 5, v14
  v_add_u32 v15, 156864, v15
  v_add_u32 v14, -5312, v15
  v_add_u32 v16, 0x10000, v13
  s_mov_b32 s61, 100000
L_poll_31:
  ds_read_b32 v26, v100 offset:40
  s_waitcnt lgkmcnt(0)
  v_cmp_ne_u32 vcc, 1, v26
  s_cbranch_vccz L_pdone_32
  s_sub_u32 s61, s61, 1
  s_cbranch_scc1 L_pdone_32
  s_sleep 2
  s_branch L_poll_31
L_pdone_32:
  ds_read_b32 v26, v100 offset:32
  s_waitcnt lgkmcnt(0)
  v_readfirstlane_b32 s55, v26
  s_cmp_eq_u32 s3, 3
  s_cbranch_scc1 L_c_b3
  s_mov_b32 s61, 100000
L_poll_33:
  ds_read_b32 v26, v100 offset:24
  s_waitcnt lgkmcnt(0)
  v_cmp_ne_u32 vcc, 8, v26
  s_cbranch_vccz L_pdone_34
  s_sub_u32 s61, s61, 1
  s_cbranch_scc1 L_pdone_34
  s_branch L_poll_33
L_pdone_34:
  s_cmp_eq_u32 s3, 2
  s_cbranch_scc1 L_c_pml
  ds_read_b128 v[56:59], v13 offset:0
  ds_read_b128 v[60:63], v13 offset:16384
  ds_read_b128 v[64:67], v13 offset:32768
  ds_read_b128 v[68:71], v13 offset:49152
  ds_read_b128 v[72:75], v16 offset:0
  ds_read_b128 v[76:79], v16 offset:16384
  ds_read_b128 v[80:83], v16 offset:32768
  ds_read_b128 v[84:87], v16 offset:49152
  s_waitcnt lgkmcnt(4)
  v_pk_add_f32 v[56:57], v[56:57], v[60:61]
  v_pk_add_f32 v[58:59], v[58:59], v[62:63]
  v_pk_add_f32 v[64:65], v[64:65], v[68:69]
  v_pk_add_f32 v[66:67], v[66:67], v[70:71]
  v_pk_add_f32 v[56:57], v[56:57], v[64:65]
  v_pk_add_f32 v[58:59], v[58:59], v[66:67]
  s_waitcnt lgkmcnt(0)
  v_pk_add_f32 v[72:73], v[72:73], v[76:77]
  v_pk_add_f32 v[74:75], v[74:75], v[78:79]
  v_pk_add_f32 v[80:81], v[80:81], v[84:85]
  v_pk_add_f32 v[82:83], v[82:83], v[86:87]
  v_pk_add_f32 v[56:57], v[56:57], v[72:73]
  v_pk_add_f32 v[58:59], v[58:59], v[74:75]
  v_pk_add_f32 v[56:57], v[56:57], v[80:81]
  v_pk_add_f32 v[58:59], v[58:59], v[82:83]
  s_cmp_eq_u32 s55, 0
  s_cbranch_scc1 L_c_oslow
  global_store_dwordx4 v11, v[56:59], s[32:33]
  s_branch L_c_b
L_c_oslow:
  global_store_dwordx4 v11, v[56:59], s[32:33] sc1
  s_branch L_c_b
L_c_pml:
  ds_read_b128 v[16:19], v14
  ds_read_b128 v[20:23], v14 offset:16
  ds_read_b128 v[28:31], v15
  ds_read_b128 v[32:35], v15 offset:16
  s_waitcnt lgkmcnt(0)
  v_max3_f32 v24, v28, v29, v30
  v_max3_f32 v24, v24, v31, v32
  v_max3_f32 v24, v24, v33, v34
  v_max_f32 v24, v24, v35
  v_add_f32 v16, v16, v17
  v_add_f32 v18, v18, v19
  v_add_f32 v20, v20, v21
  v_add_f32 v22, v22, v23
  v_add_f32 v16, v16, v18
  v_add_f32 v20, v20, v22
  v_add_f32 v25, v16, v20
  s_mov_b64 exec, 15
  s_cmp_eq_u32 s55, 0
  s_cbranch_scc1 L_c_mslow
  global_store_dwordx2 v102, v[24:25], s[32:33]
  s_branch L_c_mdone
L_c_mslow:
  global_store_dwordx2 v102, v[24:25], s[32:33] sc1
L_c_mdone:
  s_mov_b64 exec, -1
L_c_b:
  s_cmp_lg_u32 s40, 0
  s_cbranch_scc1 L_c_dexit
  s_waitcnt vmcnt(1)
  s_branch L_c_b2
L_c_dexit:
  s_branch L_c_dw
L_c_b3:
  s_waitcnt vmcnt(0)
L_c_b2:
  s_mov_b64 exec, 1
  ds_add_u32 v100, v101 offset:20
  s_mov_b64 exec, -1
  s_mov_b32 s61, 100000
L_poll_35:
  ds_read_b32 v20, v100 offset:20
  s_waitcnt lgkmcnt(0)
  v_cmp_ne_u32 vcc, 4, v20
  s_cbranch_vccz L_pdone_36
  s_sub_u32 s61, s61, 1
  s_cbranch_scc1 L_pdone_36
  s_branch L_poll_35
L_pdone_36:
  ds_read_b64_tr_b16 v[104:105], v12 offset:0
  ds_read_b64_tr_b16 v[106:107], v12 offset:512
  ds_read_b64_tr_b16 v[108:109], v12 offset:4096
  ds_read_b64_tr_b16 v[110:111], v12 offset:4608
  ds_read_b64_tr_b16 v[112:113], v12 offset:8192
  ds_read_b64_tr_b16 v[114:115], v12 offset:8704
  ds_read_b64_tr_b16 v[116:117], v12 offset:12288
  ds_read_b64_tr_b16 v[118:119], v12 offset:12800
  s_cmp_eq_u32 s63, 0
  s_cbranch_scc1 L_c_nof2
  s_waitcnt lgkmcnt(0)
  ds_read_b64_tr_b16 v[72:73], v98 offset:0
  ds_read_b64_tr_b16 v[74:75], v98 offset:512
  ds_read_b64_tr_b16 v[76:77], v98 offset:4096
  ds_read_b64_tr_b16 v[78:79], v98 offset:4608
  ds_read_b64_tr_b16 v[80:81], v98 offset:16384
  ds_read_b64_tr_b16 v[82:83], v98 offset:16896
  ds_read_b64_tr_b16 v[84:85], v98 offset:20480
  ds_read_b64_tr_b16 v[86:87], v98 offset:20992
L_c_nof2:
  s_mov_b64 s[88:89], -1
  s_mov_b64 s[90:91], -1
  s_mov_b64 s[92:93], -1
  s_mov_b64 s[94:95], -1
  s_mov_b64 s[96:97], -1
  s_mov_b64 s[98:99], -1
  s_mov_b32 s60, 100000
L_hop_37:
  s_mov_b64 exec, s[88:89]
  s_cbranch_execz L_sk_39
  global_load_dwordx4 v[32:35], v6, s[32:33] offset:0 sc1
L_sk_39:
  s_mov_b64 exec, s[90:91]
  s_cbranch_execz L_sk_40
  global_load_dwordx4 v[36:39], v6, s[32:33] offset:1024 sc1
L_sk_40:
  s_mov_b64 exec, s[92:93]
  s_cbranch_execz L_sk_41
  global_load_dwordx4 v[40:43], v6, s[32:33] offset:2048 sc1
L_sk_41:
  s_mov_b64 exec, s[94:95]
  s_cbranch_execz L_sk_42
  global_load_dwordx4 v[44:47], v6, s[32:33] offset:3072 sc1
L_sk_42:
  s_mov_b64 exec, s[96:97]
  s_cbranch_execz L_sk_43
  global_load_dwordx4 v[48:51], v7, s[32:33] sc1
L_sk_43:
  s_mov_b64 exec, s[98:99]
  s_cbranch_execz L_sk_44
  global_load_dwordx4 v[52:55], v7, s[32:33] offset:16 sc1
L_sk_44:
  s_waitcnt vmcnt(0)
  s_mov_b64 exec, s[88:89]
  v_cmp_eq_u32 s[88:89], -1, v35
  s_mov_b64 exec, s[90:91]
  v_cmp_eq_u32 s[90:91], -1, v39
  s_mov_b64 exec, s[92:93]
  v_cmp_eq_u32 s[92:93], -1, v43
  s_mov_b64 exec, s[94:95]
  v_cmp_eq_u32 s[94:95], -1, v47
  s_mov_b64 exec, s[96:97]
  v_max_u32 v20, v49, v51
  v_cmp_eq_u32 s[96:97], -1, v20
  s_mov_b64 exec, s[98:99]
  v_max_u32 v20, v53, v55
  v_cmp_eq_u32 s[98:99], -1, v20
  s_or_b64 vcc, s[88:89], s[90:91]
  s_or_b64 vcc, vcc, s[92:93]
  s_or_b64 vcc, vcc, s[94:95]
  s_or_b64 vcc, vcc, s[96:97]
  s_or_b64 vcc, vcc, s[98:99]
  s_cbranch_scc0 L_hopdone_38
  s_sub_u32 s60, s60, 1
  s_cbranch_scc0 L_hop_37
L_hopdone_38:
  s_mov_b64 exec, -1
  v_max3_f32 v20, v48, v50, v52
  v_max_f32 v20, v20, v54
  v_mov_b32 v21, v20
  s_nop 1
  v_permlane32_swap_b32 v20, v21
  s_nop 0
  v_max_f32 v20, v20, v21
  v_mul_f32 v20, s54, v20
  v_fma_f32 v56, v48, s54, -v20
  v_fma_f32 v57, v50, s54, -v20
  v_fma_f32 v58, v52, s54, -v20
  v_fma_f32 v59, v54, s54, -v20
  v_exp_f32 v56, v56
  v_exp_f32 v57, v57
  v_exp_f32 v58, v58
  v_exp_f32 v59, v59
  s_nop 0
  v_mul_f32 v20, v56, v32
  v_mul_f32 v21, v56, v33
  v_mul_f32 v22, v56, v34
  v_mul_f32 v23, v56, v35
  v_mul_f32 v24, v56, v49
  v_fma_f32 v20, v57, v36, v20
  v_fma_f32 v21, v57, v37, v21
  v_fma_f32 v22, v57, v38, v22
  v_fma_f32 v23, v57, v39, v23
  v_fma_f32 v24, v57, v51, v24
  v_fma_f32 v20, v58, v40, v20
  v_fma_f32 v21, v58, v41, v21
  v_fma_f32 v22, v58, v42, v22
  v_fma_f32 v23, v58, v43, v23
  v_fma_f32 v24, v58, v53, v24
  v_fma_f32 v20, v59, v44, v20
  v_fma_f32 v21, v59, v45, v21
  v_fma_f32 v22, v59, v46, v22
  v_fma_f32 v23, v59, v47, v23
  v_fma_f32 v24, v59, v55, v24
  v_mov_b32 v25, v20
  v_mov_b32 v26, v21
  v_mov_b32 v27, v22
  v_mov_b32 v28, v23
  v_mov_b32 v29, v24
  v_permlane32_swap_b32 v20, v25
  v_permlane32_swap_b32 v21, v26
  v_permlane32_swap_b32 v22, v27
  v_permlane32_swap_b32 v23, v28
  v_permlane32_swap_b32 v24, v29
  v_add_f32 v20, v20, v25
  v_add_f32 v21, v21, v26
  v_add_f32 v22, v22, v27
  v_add_f32 v23, v23, v28
  v_add_f32 v24, v24, v29
  v_rcp_f32 v24, v24
  s_nop 0
  v_mul_f32 v20, v20, v24
  v_mul_f32 v21, v21, v24
  v_mul_f32 v22, v22, v24
  v_mul_f32 v23, v23, v24
  v_cvt_pk_bf16_f32 v20, v20, v21
  v_cvt_pk_bf16_f32 v21, v22, v23
  s_mov_b32 exec_hi, 0
  ds_write_b64 v8, v[20:21]
  s_mov_b64 exec, -1
  s_waitcnt lgkmcnt(0)
  s_barrier
  ds_read_b128 v[128:131], v9 offset:0
  ds_read_b128 v[132:135], v9 offset:64
  ds_read_b128 v[136:139], v9 offset:128
  ds_read_b128 v[140:143], v9 offset:192
  s_waitcnt lgkmcnt(3)
  v_mfma_f32_16x16x32_bf16 v[20:23], v[128:131], v[104:107], 0
  s_waitcnt lgkmcnt(2)
  v_mfma_f32_16x16x32_bf16 v[20:23], v[132:135], v[108:111], v[20:23]
  s_waitcnt lgkmcnt(1)
  v_mfma_f32_16x16x32_bf16 v[20:23], v[136:139], v[112:115], v[20:23]
  s_waitcnt lgkmcnt(0)
  v_mfma_f32_16x16x32_bf16 v[20:23], v[140:143], v[116:119], v[20:23]
  s_cmp_eq_u32 s63, 0
  s_cbranch_scc1 L_c_one
  v_mfma_f32_16x16x32_bf16 v[24:27], v[128:131], v[72:75], 0
  v_mfma_f32_16x16x32_bf16 v[24:27], v[132:135], v[76:79], v[24:27]
  v_mfma_f32_16x16x32_bf16 v[24:27], v[136:139], v[80:83], v[24:27]
  v_mfma_f32_16x16x32_bf16 v[24:27], v[140:143], v[84:87], v[24:27]
  s_nop 1
  global_store_dword v10, v20, s[32:33] sc1
  s_nop 4
  global_store_dword v99, v24, s[32:33] sc1
  s_branch L_c_bdone
L_c_one:
  s_nop 5
  global_store_dword v10, v20, s[32:33] sc1
L_c_bdone:
  s_mov_b64 exec, -1
  s_cmp_eq_u32 s39, 0
  s_cbranch_scc1 L_chain_end
  s_lshl_b32 s46, s36, 4
  s_add_u32 s46, s46, s6
  v_lshlrev_b32 v6, 4, v0
  v_and_b32 v7, 7, v0
  s_lshl_b32 s44, s46, 12
  s_lshl_b32 s45, s3, 10
  s_add_u32 s44, s44, s45
  s_add_u32 s44, s44, 1114112
  v_add_u32 v9, s44, v6
  v_lshlrev_b32 v10, 4, v7
  v_add_u32 v10, 147456, v10
  s_lshl_b32 s45, s3, 7
  v_add_u32 v11, s45, v10
  s_lshl_b32 s44, s36, 11
  s_lshl_b32 s45, s6, 7
  s_add_u32 s44, s44, s45
  s_add_u32 s44, s44, 1835008
  v_lshrrev_b32 v8, 3, v0
  v_lshlrev_b32 v8, 13, v8
  v_lshl_add_u32 v8, v7, 4, v8
  v_add_u32 v8, s44, v8
  v_lshlrev_b32 v110, 16, v120
  v_and_b32 v111, 0xffff0000, v120
  v_lshlrev_b32 v112, 16, v121
  v_and_b32 v113, 0xffff0000, v121
  v_lshlrev_b32 v114, 16, v122
  v_and_b32 v115, 0xffff0000, v122
  v_lshlrev_b32 v116, 16, v123
  v_and_b32 v117, 0xffff0000, v123
  s_mov_b32 s60, 100000
L_p1_45:
  global_load_dwordx4 v[16:19], v9, s[32:33] sc1
  s_waitcnt vmcnt(0)
  v_cmp_eq_u32 vcc, -1, v19
  s_cbranch_vccz L_p1d_46
  s_mov_b64 exec, vcc
  s_sub_u32 s60, s60, 1
  s_cbranch_scc0 L_p1_45
L_p1d_46:
  s_mov_b64 exec, -1
  v_add_f32_dpp v16, v16, v16 row_ror:8 row_mask:0xf bank_mask:0xf
  v_add_f32_dpp v17, v17, v17 row_ror:8 row_mask:0xf bank_mask:0xf
  v_add_f32_dpp v18, v18, v18 row_ror:8 row_mask:0xf bank_mask:0xf
  v_add_f32_dpp v19, v19, v19 row_ror:8 row_mask:0xf bank_mask:0xf
  v_mov_b32 v24, v16
  v_mov_b32 v25, v17
  v_mov_b32 v26, v18
  v_mov_b32 v27, v19
  v_permlane16_swap_b32 v16, v24
  v_permlane16_swap_b32 v17, v25
  v_permlane16_swap_b32 v18, v26
  v_permlane16_swap_b32 v19, v27
  v_add_f32 v16, v16, v24
  v_add_f32 v17, v17, v25
  v_add_f32 v18, v18, v26
  v_add_f32 v19, v19, v27
  v_mov_b32 v24, v16
  v_mov_b32 v25, v17
  v_mov_b32 v26, v18
  v_mov_b32 v27, v19
  v_permlane32_swap_b32 v16, v24
  v_permlane32_swap_b32 v17, v25
  v_permlane32_swap_b32 v18, v26
  v_permlane32_swap_b32 v19, v27
  v_add_f32 v16, v16, v24
  v_add_f32 v17, v17, v25
  v_add_f32 v18, v18, v26
  v_add_f32 v19, v19, v27
  s_mov_b64 exec, 0xff
  ds_write_b128 v11, v[16:19]
  s_mov_b64 exec, -1
  s_waitcnt lgkmcnt(0)
  s_barrier
  s_cmp_eq_u32 s3, 0
  s_cbranch_scc1 L_c_c0
  s_barrier
  s_branch L_chain_end
L_c_c0:
  ds_read_b128 v[32:35], v10 offset:0
  ds_read_b128 v[36:39], v10 offset:128
  ds_read_b128 v[40:43], v10 offset:256
  ds_read_b128 v[44:47], v10 offset:384
  s_waitcnt lgkmcnt(0)
  v_pk_add_f32 v[16:17], v[32:33], v[36:37]
  v_pk_add_f32 v[18:19], v[34:35], v[38:39]
  v_pk_add_f32 v[20:21], v[40:41], v[44:45]
  v_pk_add_f32 v[22:23], v[42:43], v[46:47]
  v_pk_add_f32 v[16:17], v[16:17], v[20:21]
  v_pk_add_f32 v[18:19], v[18:19], v[22:23]
  v_cvt_pk_bf16_f32 v24, v16, v17
  v_cvt_pk_bf16_f32 v25, v18, v19
  v_lshlrev_b32 v16, 16, v24
  v_and_b32 v17, 0xffff0000, v24
  v_lshlrev_b32 v18, 16, v25
  v_and_b32 v19, 0xffff0000, v25
  v_add_f32 v16, v16, v110
  v_add_f32 v17, v17, v111
  v_add_f32 v18, v18, v112
  v_add_f32 v19, v19, v113
  v_cvt_pk_bf16_f32 v24, v16, v17
  v_cvt_pk_bf16_f32 v25, v18, v19
  v_lshlrev_b32 v104, 16, v24
  v_and_b32 v105, 0xffff0000, v24
  v_lshlrev_b32 v106, 16, v25
  v_and_b32 v107, 0xffff0000, v25
  global_store_dwordx4 v8, v[104:107], s[32:33] sc1
  s_barrier
  ds_read_b128 v[32:35], v10 offset:1024
  ds_read_b128 v[36:39], v10 offset:1152
  ds_read_b128 v[40:43], v10 offset:1280
  ds_read_b128 v[44:47], v10 offset:1408
  ds_read_b128 v[48:51], v10 offset:1536
  ds_read_b128 v[52:55], v10 offset:1664
  ds_read_b128 v[56:59], v10 offset:1792
  s_waitcnt lgkmcnt(3)
  v_pk_add_f32 v[16:17], v[32:33], v[36:37]
  v_pk_add_f32 v[18:19], v[34:35], v[38:39]
  v_pk_add_f32 v[20:21], v[40:41], v[44:45]
  v_pk_add_f32 v[22:23], v[42:43], v[46:47]
  s_waitcnt lgkmcnt(0)
  v_pk_add_f32 v[24:25], v[48:49], v[52:53]
  v_pk_add_f32 v[26:27], v[50:51], v[54:55]
  v_pk_add_f32 v[16:17], v[16:17], v[56:57]
  v_pk_add_f32 v[18:19], v[18:19], v[58:59]
  v_pk_add_f32 v[20:21], v[20:21], v[24:25]
  v_pk_add_f32 v[22:23], v[22:23], v[26:27]
  v_pk_add_f32 v[16:17], v[16:17], v[20:21]
  v_pk_add_f32 v[18:19], v[18:19], v[22:23]
  v_cvt_pk_bf16_f32 v24, v16, v17
  v_cvt_pk_bf16_f32 v25, v18, v19
  v_lshlrev_b32 v16, 16, v24
  v_and_b32 v17, 0xffff0000, v24
  v_lshlrev_b32 v18, 16, v25
  v_and_b32 v19, 0xffff0000, v25
  v_add_f32 v16, v16, v114
  v_add_f32 v17, v17, v115
  v_add_f32 v18, v18, v116
  v_add_f32 v19, v19, v117
  v_cvt_pk_bf16_f32 v24, v16, v17
  v_cvt_pk_bf16_f32 v25, v18, v19
  v_lshlrev_b32 v16, 16, v24
  v_and_b32 v17, 0xffff0000, v24
  v_lshlrev_b32 v18, 16, v25
  v_and_b32 v19, 0xffff0000, v25
  v_add_f32 v16, v16, v104
  v_add_f32 v17, v17, v105
  v_add_f32 v18, v18, v106
  v_add_f32 v19, v19, v107
  v_cvt_pk_bf16_f32 v24, v16, v17
  v_cvt_pk_bf16_f32 v25, v18, v19
  s_mov_b64 exec, 0xff
  global_store_dwordx2 v126, v[24:25], s[28:29]
  s_or_b32 s44, s36, s6
  s_cmp_lg_u32 s44, 0
  s_cbranch_scc1 L_c_noe
  s_mov_b64 exec, 1
  v_mov_b32 v8, 0
  v_mov_b32 v9, s42
  global_store_dword v8, v9, s[32:33] sc1
L_c_noe:
  s_mov_b64 exec, -1
L_chain_end:
L_exit:
  s_endpgm
L_code_end:
  .fill 256, 4, 0xbf800000
.section .rodata,"a"
.p2align 6
.amdhsa_kernel sequential_preLN__gqa_block_cached__mixer_channel_mlp__decode_kernel
  .amdhsa_next_free_vgpr 168
  .amdhsa_next_free_sgpr 102
  .amdhsa_accum_offset 168
  .amdhsa_group_segment_fixed_size 0
  .amdhsa_kernarg_size 104
  .amdhsa_user_sgpr_count 2
  .amdhsa_user_sgpr_kernarg_segment_ptr 1
  .amdhsa_system_sgpr_workgroup_id_x 1
.end_amdhsa_kernel
```
